```python
import torch

def _softmax(x, axis=-1):
    return torch.softmax(x, dim=axis)
def _gelu(x):
    return torch.nn.functional.gelu(x, approximate="tanh")
def _silu(x):
    return torch.nn.functional.silu(x)
def _sigmoid(x):
    return torch.sigmoid(x)
def _layernorm(x, axis=-1, eps=1e-5):
    m = x.mean(dim=axis, keepdim=True)
    v = x.var(dim=axis, keepdim=True, unbiased=False)
    return (x - m) / torch.sqrt(v + eps)
def _scatter_add(tgt, idx, src, axis=0):
    return tgt.clone().index_add_(axis, idx, src)
def _segment_sum(src, seg, n):
    out = torch.zeros((n,) + src.shape[1:], dtype=src.dtype)
    return out.index_add_(0, seg, src)
def _pad(x, pw):
    flat = tuple(v for pair in reversed(pw) for v in pair)
    return torch.nn.functional.pad(x, flat)

kernel_name = 'recurrent_scan__softmax_full_mha__dense_activation_squared_relu__prompt'

def setup_inputs():

    _w = (lambda a: (lambda t: t.to(torch.bfloat16) if t.is_floating_point() else t)(torch.as_tensor(a)))
    def _A_setup():
        B, S, D = 1, 2048, 512
        return {
            "x": _w((lambda *s: torch.randn(*s, dtype=torch.bfloat16) * 0.05)(B, S, D)),
            "wqkv": _w((lambda *s: torch.randn(*s, dtype=torch.bfloat16) * 0.05)(D, 3 * D)),
            "wo": _w((lambda *s: torch.randn(*s, dtype=torch.bfloat16) * 0.05)(D, D)),
        }
    _A_in = _A_setup()

    def _B_setup():
        B, S, D, F = 1, 2048, 512, 1376
        return {
            "x": _w((lambda *s: torch.randn(*s, dtype=torch.bfloat16) * 0.05)(B, S, D)),
            "w1": _w((lambda *s: torch.randn(*s, dtype=torch.bfloat16) * 0.05)(D, F)),
            "b1": _w((lambda *s: torch.randn(*s, dtype=torch.bfloat16) * 0.8)(F)),
            "w2": _w((lambda *s: torch.randn(*s, dtype=torch.bfloat16) * 0.05)(F, D)),
            "b2": _w((lambda *s: torch.randn(*s, dtype=torch.bfloat16) * 1.6)(D)),
        }
    _B_in = _B_setup()

    return {
        "A_x": _A_in["x"],
        "A_wqkv": _A_in["wqkv"],
        "A_wo": _A_in["wo"],
        "B_x": _B_in["x"],
        "B_w1": _B_in["w1"],
        "B_b1": _B_in["b1"],
        "B_w2": _B_in["w2"],
        "B_b2": _B_in["b2"],
    }

def reference(A_x, A_wqkv, A_wo, B_x, B_w1, B_b1, B_w2, B_b2):
    def _A_ref(x, wqkv, wo):
        B, S, D = x.shape
        H = 32; Dh = D // H
        qkv = (lambda x, *d: x.permute(*d))((x @ wqkv).reshape(B, S, 3, H, Dh), 2, 0, 3, 1, 4)
        q, k, v = qkv[0], qkv[1], qkv[2]
        scale = Dh ** -0.5
        scores = torch.einsum("bhqd,bhkd->bhqk", q, k) * scale
        p = _softmax(scores, axis=-1)
        o = torch.einsum("bhqk,bhkd->bhqd", p, v)
        return (lambda x, *d: x.permute(*d))(o, 0, 2, 1, 3).reshape(B, S, D) @ wo

    def _B_ref(x, w1, b1, w2, b2):
        h = torch.einsum("bsd,df->bsf", x, w1) + b1
        zero = torch.zeros_like(h)
        r = torch.where(h > zero, h, zero)
        h = r * r
        out = torch.einsum("bsf,fd->bsd", h, w2) + b2
        return out

    x = A_x
    xn = _layernorm(x, axis=-1)
    s = _A_ref(xn, A_wqkv, A_wo)
    g = _silu(_B_ref(xn, B_w1, B_b1, B_w2, B_b2))
    return x + s * g
```

```asm
; @launch grid=(256,1,1) block=(512,1,1) lds=163840
.amdgcn_target "amdgcn-amd-amdhsa--gfx950"
.text
.globl recurrent_scan__softmax_full_mha__dense_activation_squared_relu__prompt_kernel
.p2align 8
.type recurrent_scan__softmax_full_mha__dense_activation_squared_relu__prompt_kernel,@function
recurrent_scan__softmax_full_mha__dense_activation_squared_relu__prompt_kernel:
    s_load_dwordx2 s[28:29], s[0:1], 0
    s_load_dwordx2 s[32:33], s[0:1], 8
    v_readfirstlane_b32 s68, v0
    s_lshr_b32 s70, s2, 1
    s_and_b32 s70, s70, 15
    s_andn2_b32 s77, 1, s2
    s_lshr_b32 s71, s2, 5
    s_lshl1_add_u32 s71, s71, s77
    s_lshl2_add_u32 s72, s77, s2
    s_and_b32 s72, s72, 6
    s_lshr_b32 s68, s68, 6
    s_mov_b32 s31, 0x20000
    s_lshl_b32 s30, 1, 21
    s_cmp_ge_u32 s68, 4
    s_cbranch_scc1 L_C
    s_movk_i32 s75, 0x70
    v_lshlrev_b32 v4, 4, v0
    v_and_b32 v2, 56, v0
    v_xor_b32 v1, v4, v2
    v_and_b32 v1, s75, v1
    v_lshl_add_u32 v172, v2, 7, v1
    v_xor_b32 v173, 64, v172
    s_lshl2_add_u32 s77, s70, s68
    s_lshl_b32 s77, s77, 8
    s_add_u32 s77, s77, s72
    s_lshl_b32 s77, s77, 7
    s_lshl_b32 m0, s68, 12
    v_lshlrev_b32 v3, 2, v0
    v_and_b32 v3, 64, v3
    v_xor_b32 v3, v3, v4
    v_and_b32 v3, s75, v3
    s_movk_i32 s76, 384
    v_mad_u32_u24 v151, v2, s76, v3
    s_lshl2_add_u32 s78, s72, s68
    s_mulk_i32 s78, 384
    s_add_u32 s78, s78, s71
    s_lshl_b32 s78, s78, 7
    s_mov_b32 s35, s31
    s_lshl1_add_u32 s75, s68, 15
    s_waitcnt lgkmcnt(0)
    buffer_load_dwordx4 v172, s[28:31], s77 offen offset:0 lds
    s_addk_i32 s77, 7168
    buffer_load_dwordx4 v173, s[28:31], s77 offen offset:1024 lds
    s_addk_i32 s77, 7168
    buffer_load_dwordx4 v172, s[28:31], s77 offen offset:2048 lds
    s_addk_i32 s77, 7168
    buffer_load_dwordx4 v173, s[28:31], s77 offen offset:3072 lds
    s_lshl_b32 m0, s75, 10
    s_lshl_b32 s34, 3, 19
    buffer_load_dwordx4 v151, s[32:35], s78 offen offset:1024 lds
    s_addk_i32 s78, 23552
    buffer_load_dwordx4 v151, s[32:35], s78 offen offset:2048 lds
    s_cmpk_ge_u32 s2, 256
    s_cbranch_scc1 L_exit
    s_lshl2_add_u32 s77, s70, s68
    s_lshl_b32 s77, s77, 15
    v_add_u32 v172, s77, v172
    v_xor_b32 v173, 64, v172
    v_add_u32 v174, 14336, v172
    v_add_u32 v175, 21504, v173
    v_add_u32 v173, 7168, v173
    s_mul_i32 s78, s68, 384
    s_add_u32 s78, s78, s71
    s_add_u32 s78, s78, 8
    s_lshl_b32 s78, s78, 7
    v_add_u32 v151, s78, v151
    v_add_u32 v152, 23552, v151
    s_lshl_b32 s75, s68, 12
    s_lshl_b32 s76, s68, 11
    s_add_u32 s73, s72, 1
    s_and_b32 s73, s73, 7
    s_lshl_b32 s73, s73, 7
    s_add_u32 m0, s75, 24576
    s_mul_i32 s77, s73, 1536
    buffer_load_dwordx4 v172, s[28:31], s73 offen offset:0 lds
    s_load_dwordx16 s[4:19], s[0:1], 0
    s_load_dwordx4 s[20:23], s[0:1], 64
    s_load_dwordx2 s[24:25], s[0:1], 80
    v_and_b32 v252, 63, v0
    v_bfe_u32 v253, v0, 5, 1
    v_and_b32 v254, 31, v0
    v_bfe_u32 v1, v0, 4, 1
    v_and_b32 v2, 3, v0
    v_lshlrev_b32 v2, 3, v2
    v_lshl_add_u32 v255, v1, 5, v2
    buffer_load_dwordx4 v173, s[28:31], s73 offen offset:1024 lds
    s_and_b32 s69, s68, 3
    s_lshr_b32 s79, s71, 3
    s_and_b32 s71, s71, 7
    s_lshl1_add_u32 s71, s71, s79
    s_waitcnt lgkmcnt(0)
    s_mov_b32 s36, s8
    s_mov_b32 s37, s9
    s_mov_b32 s38, 524288
    s_mov_b32 s39, 0x20000
    s_mov_b32 s40, s12
    buffer_load_dwordx4 v174, s[28:31], s73 offen offset:2048 lds
    s_mov_b32 s41, s13
    s_mov_b32 s42, 1409024
    s_mov_b32 s43, 0x20000
    s_mov_b32 s44, s16
    s_mov_b32 s45, s17
    s_mov_b32 s46, 1409024
    s_mov_b32 s47, 0x20000
    s_mov_b32 s48, s20
    s_mov_b32 s49, s21
    s_mov_b32 s50, 2097152
    buffer_load_dwordx4 v175, s[28:31], s73 offen offset:3072 lds
    s_mov_b32 s51, 0x20000
    s_mov_b32 s52, s24
    s_mov_b32 s53, s25
    s_mov_b32 s54, 14680064
    s_mov_b32 s55, 0x20000
    s_mov_b32 s56, s14
    s_mov_b32 s57, s15
    s_mov_b32 s58, 2752
    s_mov_b32 s59, 0x20000
    s_mov_b32 s60, s18
    s_add_u32 m0, s76, 40960
    s_add_u32 s73, s73, 128
    s_and_b32 s73, s73, 0x3ff
    buffer_load_dwordx4 v151, s[32:35], s77 offen offset:0 lds
    s_mov_b32 s61, s19
    s_mov_b32 s62, 1024
    s_mov_b32 s63, 0x20000
    s_mov_b32 s64, s22
    s_mov_b32 s65, s23
    s_mov_b32 s66, 256
    s_mov_b32 s67, 0x20000
    s_xor_b32 s10, s71, 2
    s_mul_i32 s10, s10, 3
    s_lshl_b32 s3, s70, 4
    buffer_load_dwordx4 v152, s[32:35], s77 offen offset:1024 lds
    s_add_u32 s3, s3, s71
    s_lshl_b32 s3, s3, 7
    s_add_u32 s3, s3, 11927552
    s_mov_b32 s26, 0xffff
    s_mov_b32 s27, 0xffff
    s_mul_i32 s2, s69, 49152
    s_lshl_b32 s79, s71, 6
    s_add_u32 s2, s2, s79
    s_mul_i32 s11, s69, 44032
    s_lshl_b32 s79, s10, 6
    s_add_u32 m0, s75, 49152
    s_mul_i32 s77, s73, 1536
    buffer_load_dwordx4 v172, s[28:31], s73 offen offset:0 lds
    s_add_u32 s11, s11, s79
    s_lshl_b32 s8, s69, 10
    s_mul_i32 s9, s69, 3072
    v_lshrrev_b32 v162, 2, v252
    v_mul_u32_u24 v162, 3072, v162
    v_and_b32 v153, 3, v252
    v_lshl_add_u32 v153, v153, 4, v162
    v_add_u32 v153, s2, v153
    s_sub_i32 s79, 43, s10
    s_lshl_b32 s79, s79, 2
    buffer_load_dwordx4 v173, s[28:31], s73 offen offset:1024 lds
    v_mov_b32 v165, 0x40000000
    v_add_u32 v162, 0, v252
    v_mul_u32_u24 v163, 171, v162
    v_lshrrev_b32 v163, 11, v163
    v_mul_u32_u24 v164, 2560, v163
    v_lshl_add_u32 v154, v252, 4, v164
    v_mul_u32_u24 v163, 12, v163
    v_sub_u32 v163, v162, v163
    v_cmp_gt_i32 vcc, s79, v163
    v_add_u32 v154, s11, v154
    buffer_load_dwordx4 v174, s[28:31], s73 offen offset:2048 lds
    v_cndmask_b32 v154, v165, v154, vcc
    v_add_u32 v162, 64, v252
    v_mul_u32_u24 v163, 171, v162
    v_lshrrev_b32 v163, 11, v163
    v_mul_u32_u24 v164, 2560, v163
    v_lshl_add_u32 v155, v252, 4, v164
    v_mul_u32_u24 v163, 12, v163
    v_sub_u32 v163, v162, v163
    v_cmp_gt_i32 vcc, s79, v163
    v_add_u32 v155, s11, v155
    buffer_load_dwordx4 v175, s[28:31], s73 offen offset:3072 lds
    v_cndmask_b32 v155, v165, v155, vcc
    v_add_u32 v162, 128, v252
    v_mul_u32_u24 v163, 171, v162
    v_lshrrev_b32 v163, 11, v163
    v_mul_u32_u24 v164, 2560, v163
    v_lshl_add_u32 v156, v252, 4, v164
    v_mul_u32_u24 v163, 12, v163
    v_sub_u32 v163, v162, v163
    v_cmp_gt_i32 vcc, s79, v163
    v_add_u32 v156, s11, v156
    s_add_u32 m0, s76, 65536
    s_add_u32 s73, s73, 128
    s_and_b32 s73, s73, 0x3ff
    buffer_load_dwordx4 v151, s[32:35], s77 offen offset:0 lds
    v_cndmask_b32 v156, v165, v156, vcc
    v_and_b32 v158, 15, v252
    v_lshlrev_b32 v158, 2, v158
    buffer_load_dwordx4 v152, s[32:35], s77 offen offset:1024 lds
    s_waitcnt vmcnt(12)
    s_barrier
    s_add_u32 m0, s75, 73728
    s_mul_i32 s77, s73, 1536
    buffer_load_dwordx4 v172, s[28:31], s73 offen offset:0 lds
    buffer_load_dwordx4 v173, s[28:31], s73 offen offset:1024 lds
    buffer_load_dwordx4 v174, s[28:31], s73 offen offset:2048 lds
    buffer_load_dwordx4 v175, s[28:31], s73 offen offset:3072 lds
    s_add_u32 m0, s76, 90112
    s_add_u32 s73, s73, 128
    s_and_b32 s73, s73, 0x3ff
    buffer_load_dwordx4 v151, s[32:35], s77 offen offset:0 lds
    buffer_load_dwordx4 v152, s[32:35], s77 offen offset:1024 lds
    s_waitcnt vmcnt(12)
    s_barrier
    s_add_u32 m0, s75, 98304
    s_mul_i32 s77, s73, 1536
    buffer_load_dwordx4 v172, s[28:31], s73 offen offset:0 lds
    buffer_load_dwordx4 v173, s[28:31], s73 offen offset:1024 lds
    buffer_load_dwordx4 v174, s[28:31], s73 offen offset:2048 lds
    buffer_load_dwordx4 v175, s[28:31], s73 offen offset:3072 lds
    s_add_u32 m0, s76, 114688
    s_add_u32 s73, s73, 128
    s_and_b32 s73, s73, 0x3ff
    buffer_load_dwordx4 v151, s[32:35], s77 offen offset:0 lds
    buffer_load_dwordx4 v152, s[32:35], s77 offen offset:1024 lds
    s_waitcnt vmcnt(12)
    s_barrier
    s_add_u32 m0, s75, 122880
    s_mul_i32 s77, s73, 1536
    buffer_load_dwordx4 v172, s[28:31], s73 offen offset:0 lds
    buffer_load_dwordx4 v173, s[28:31], s73 offen offset:1024 lds
    buffer_load_dwordx4 v174, s[28:31], s73 offen offset:2048 lds
    buffer_load_dwordx4 v175, s[28:31], s73 offen offset:3072 lds
    s_add_u32 m0, s76, 139264
    s_add_u32 s73, s73, 128
    s_and_b32 s73, s73, 0x3ff
    buffer_load_dwordx4 v151, s[32:35], s77 offen offset:0 lds
    buffer_load_dwordx4 v152, s[32:35], s77 offen offset:1024 lds
    s_waitcnt vmcnt(12)
    s_barrier
    s_add_u32 m0, s75, 0
    s_mul_i32 s77, s73, 1536
    buffer_load_dwordx4 v172, s[28:31], s73 offen offset:0 lds
    buffer_load_dwordx4 v173, s[28:31], s73 offen offset:1024 lds
    buffer_load_dwordx4 v174, s[28:31], s73 offen offset:2048 lds
    buffer_load_dwordx4 v175, s[28:31], s73 offen offset:3072 lds
    s_add_u32 m0, s76, 16384
    s_add_u32 s73, s73, 128
    s_and_b32 s73, s73, 0x3ff
    buffer_load_dwordx4 v151, s[32:35], s77 offen offset:0 lds
    buffer_load_dwordx4 v152, s[32:35], s77 offen offset:1024 lds
    s_waitcnt vmcnt(12)
    s_barrier
    s_add_u32 m0, s75, 24576
    s_mul_i32 s77, s73, 1536
    buffer_load_dwordx4 v172, s[28:31], s73 offen offset:0 lds
    buffer_load_dwordx4 v173, s[28:31], s73 offen offset:1024 lds
    buffer_load_dwordx4 v174, s[28:31], s73 offen offset:2048 lds
    buffer_load_dwordx4 v175, s[28:31], s73 offen offset:3072 lds
    s_add_u32 m0, s76, 40960
    s_add_u32 s73, s73, 128
    s_and_b32 s73, s73, 0x3ff
    buffer_load_dwordx4 v151, s[32:35], s77 offen offset:0 lds
    buffer_load_dwordx4 v152, s[32:35], s77 offen offset:1024 lds
    s_waitcnt vmcnt(12)
    s_barrier
    s_add_u32 m0, s8, 49152
    s_mul_i32 s77, s73, 1536
    buffer_load_dwordx4 v153, s[32:35], s77 offen offset:0 lds
    s_add_u32 s73, s73, 128
    s_and_b32 s73, s73, 0x3ff
    s_add_u32 m0, s8, 53248
    s_mul_i32 s77, s73, 1536
    buffer_load_dwordx4 v153, s[32:35], s77 offen offset:0 lds
    s_add_u32 s73, s73, 128
    s_and_b32 s73, s73, 0x3ff
    s_add_u32 m0, s8, 57344
    s_mul_i32 s77, s73, 1536
    buffer_load_dwordx4 v153, s[32:35], s77 offen offset:0 lds
    s_add_u32 s73, s73, 128
    s_and_b32 s73, s73, 0x3ff
    s_add_u32 m0, s8, 61440
    s_mul_i32 s77, s73, 1536
    buffer_load_dwordx4 v153, s[32:35], s77 offen offset:0 lds
    s_add_u32 s73, s73, 128
    s_and_b32 s73, s73, 0x3ff
    s_waitcnt vmcnt(10)
    s_barrier
    s_add_u32 m0, s8, 65536
    s_mul_i32 s77, s73, 1536
    buffer_load_dwordx4 v153, s[32:35], s77 offen offset:0 lds
    s_add_u32 s73, s73, 128
    s_and_b32 s73, s73, 0x3ff
    s_add_u32 m0, s8, 69632
    s_mul_i32 s77, s73, 1536
    buffer_load_dwordx4 v153, s[32:35], s77 offen offset:0 lds
    s_add_u32 s73, s73, 128
    s_and_b32 s73, s73, 0x3ff
    s_add_u32 m0, s8, 73728
    s_mul_i32 s77, s73, 1536
    buffer_load_dwordx4 v153, s[32:35], s77 offen offset:0 lds
    s_add_u32 s73, s73, 128
    s_and_b32 s73, s73, 0x3ff
    s_add_u32 m0, s8, 77824
    s_mul_i32 s77, s73, 1536
    buffer_load_dwordx4 v153, s[32:35], s77 offen offset:0 lds
    s_add_u32 s73, s73, 128
    s_and_b32 s73, s73, 0x3ff
    s_waitcnt vmcnt(8)
    s_barrier
    s_mov_b64 exec, 0xffff
    buffer_load_dword v168, v158, s[64:67], 0 offen sc1
    s_mov_b64 exec, -1
    s_add_u32 m0, s9, 81920
    s_mul_i32 s77, s73, 1376
    buffer_load_dwordx4 v154, s[40:43], s77 offen offset:0 lds
    buffer_load_dwordx4 v155, s[40:43], s77 offen offset:1024 lds
    buffer_load_dwordx4 v156, s[40:43], s77 offen offset:2048 lds
    s_add_u32 s73, s73, 128
    s_and_b32 s73, s73, 0x3ff
    s_waitcnt vmcnt(8)
    s_barrier
    s_add_u32 m0, s9, 94208
    s_mul_i32 s77, s73, 1376
    buffer_load_dwordx4 v154, s[40:43], s77 offen offset:0 lds
    buffer_load_dwordx4 v155, s[40:43], s77 offen offset:1024 lds
    buffer_load_dwordx4 v156, s[40:43], s77 offen offset:2048 lds
    s_add_u32 s73, s73, 128
    s_and_b32 s73, s73, 0x3ff
    s_add_u32 m0, s9, 106496
    s_mul_i32 s77, s73, 1376
    buffer_load_dwordx4 v154, s[40:43], s77 offen offset:0 lds
    buffer_load_dwordx4 v155, s[40:43], s77 offen offset:1024 lds
    buffer_load_dwordx4 v156, s[40:43], s77 offen offset:2048 lds
    s_add_u32 s73, s73, 128
    s_and_b32 s73, s73, 0x3ff
    s_add_u32 m0, s9, 118784
    s_mul_i32 s77, s73, 1376
    buffer_load_dwordx4 v154, s[40:43], s77 offen offset:0 lds
    buffer_load_dwordx4 v155, s[40:43], s77 offen offset:1024 lds
    buffer_load_dwordx4 v156, s[40:43], s77 offen offset:2048 lds
    s_add_u32 s73, s73, 128
    s_and_b32 s73, s73, 0x3ff
    s_waitcnt vmcnt(13)
    s_barrier
    s_lshr_b32 s18, s68, 2
    s_lshl_b32 s19, s71, 1
    s_add_u32 s19, s19, s18
    s_lshl_b32 s4, s19, 17
    s_lshl_b32 s14, s19, 10
    s_lshl_b32 s19, s69, 11
    s_add_u32 s4, s4, s19
    s_mov_b32 s5, s4
    s_lshl_b32 s19, s70, 2
    s_add_u32 s19, s19, s69
    s_lshl_b32 s19, s19, 15
    s_add_u32 s14, s14, s19
    s_add_u32 s14, s14, 9830400
    s_lshr_b32 s18, s68, 1
    s_mul_i32 s13, s18, 22
    s_lshl_b32 s12, s68, 10
    s_and_b32 s18, s68, 1
    s_lshl_b32 s7, s13, 1
    s_add_u32 s7, s7, s18
    s_lshl_b32 s7, s7, 13
    s_lshr_b32 s19, s71, 1
    s_lshl_b32 s19, s19, 7
    s_add_u32 s7, s7, s19
    s_add_u32 s7, s7, 147456
    s_and_b32 s6, s71, 1
    s_lshl_b32 s15, s70, 1
    s_add_u32 s15, s15, s6
    s_lshl_b32 s6, s15, 1
    s_add_u32 s6, s6, s18
    s_mul_i32 s6, s6, 88064
    s_add_u32 s6, s6, 4194304
    s_lshl_b32 s15, s15, 3
    s_add_u32 s15, s15, s69
    s_lshl_b32 s15, s15, 13
    s_add_u32 s15, s15, s19
    s_lshr_b32 s16, s71, 1
    s_and_b32 s18, s70, 3
    s_lshl2_add_u32 s16, s16, s18
    s_lshl2_add_u32 s16, s16, s69
    s_lshl_b32 s16, s16, 8
    s_add_u32 s16, s16, 11927552
    s_mov_b32 s17, 14680064
    s_mov_b32 s24, 14680064
    v_lshlrev_b32 v237, 4, v252
    v_and_b32 v238, 15, v252
    v_lshlrev_b32 v238, 4, v238
    v_lshl_add_u32 v238, v253, 8, v238
    v_mov_b32 v236, 0xdddddddd
    v_bfe_u32 v162, v252, 4, 1
    v_lshlrev_b32 v162, 2, v162
    v_and_b32 v239, 7, v252
    v_xor_b32 v239, v239, v162
    v_lshlrev_b32 v239, 4, v239
    v_lshrrev_b32 v162, 3, v252
    v_mul_u32_u24 v162, 1024, v162
    v_add_u32 v239, v239, v162
    v_and_b32 v124, 27, v252
    v_cmp_eq_u32 vcc, 16, v124
    v_mov_b32 v125, 0x3f803f80
    s_nop 0
    v_cndmask_b32 v124, 0, v125, vcc
    v_cndmask_b32 v125, 0, v125, vcc
    v_mov_b64 v[126:127], v[124:125]
    v_mov_b64 v[128:129], v[124:125]
    v_mov_b64 v[130:131], v[124:125]
    v_mov_b64 v[132:133], v[124:125]
    v_mov_b64 v[134:135], v[124:125]
    v_mov_b64 v[136:137], v[124:125]
    v_mov_b64 v[138:139], v[124:125]
    v_mov_b64 v[140:141], v[124:125]
    v_mov_b64 v[142:143], v[124:125]
    v_mov_b64 v[144:145], v[124:125]
    v_mov_b64 v[146:147], v[124:125]
    s_waitcnt vmcnt(6)
    s_mov_b64 exec, 0xffff
    s_mov_b32 s79, 262144
    s_branch L_pollc1
L_poll1:
    buffer_load_dword v168, v158, s[64:67], 0 offen sc1
    s_waitcnt vmcnt(0)
L_pollc1:
    v_cmp_eq_u32 vcc, 0, v168
    s_nop 1
    s_cmp_eq_u64 vcc, 0
    s_cbranch_scc1 L_polld1
    s_sub_u32 s79, s79, 1
    s_cmp_lg_u32 s79, 0
    s_cbranch_scc1 L_poll1
L_polld1:
    s_mov_b64 exec, -1
    s_barrier
    s_add_u32 m0, s9, 131072
    s_mul_i32 s77, s73, 1376
    buffer_load_dwordx4 v154, s[40:43], s77 offen offset:0 lds
    buffer_load_dwordx4 v155, s[40:43], s77 offen offset:1024 lds
    buffer_load_dwordx4 v156, s[40:43], s77 offen offset:2048 lds
    s_add_u32 s73, s73, 128
    s_and_b32 s73, s73, 0x3ff
    s_barrier
    s_add_u32 m0, s9, 0
    s_mul_i32 s77, s73, 1376
    buffer_load_dwordx4 v154, s[40:43], s77 offen offset:0 lds
    buffer_load_dwordx4 v155, s[40:43], s77 offen offset:1024 lds
    buffer_load_dwordx4 v156, s[40:43], s77 offen offset:2048 lds
    s_add_u32 s73, s73, 128
    s_and_b32 s73, s73, 0x3ff
    s_waitcnt vmcnt(6)
    s_barrier
    s_add_u32 m0, s9, 12288
    s_mul_i32 s77, s73, 1376
    buffer_load_dwordx4 v154, s[40:43], s77 offen offset:0 lds
    buffer_load_dwordx4 v155, s[40:43], s77 offen offset:1024 lds
    buffer_load_dwordx4 v156, s[40:43], s77 offen offset:2048 lds
    s_add_u32 s73, s73, 128
    s_and_b32 s73, s73, 0x3ff
    s_add_u32 m0, s9, 24576
    s_mul_i32 s77, s73, 1376
    buffer_load_dwordx4 v154, s[40:43], s77 offen offset:0 lds
    buffer_load_dwordx4 v155, s[40:43], s77 offen offset:1024 lds
    buffer_load_dwordx4 v156, s[40:43], s77 offen offset:2048 lds
    s_waitcnt vmcnt(6)
    s_barrier
    s_mov_b64 exec, 1
    v_mov_b32 v168, 0
    buffer_atomic_umax v168, off, s[52:55], s16 offset:48 sc0 sc1
    s_mov_b64 exec, -1
    s_lshl_b32 s73, s68, 10
    s_add_u32 s73, s73, 147456
    v_lshl_add_u32 v244, v252, 4, s73
    ds_read_b128 v[96:99], v244
    v_xor_b32 v245, 1024, v244
    ds_read_b128 v[100:103], v245
    v_xor_b32 v246, 2048, v244
    ds_read_b128 v[104:107], v246
    v_xor_b32 v247, 3072, v244
    ds_read_b128 v[108:111], v247
    s_waitcnt vmcnt(1) lgkmcnt(0)
    s_barrier
    s_waitcnt vmcnt(0)
    s_mov_b64 exec, 1
    s_mov_b32 s79, 262144
    s_branch L_pollc2
L_poll2:
    buffer_atomic_umax v168, off, s[52:55], s16 offset:48 sc0 sc1
    s_waitcnt vmcnt(0)
L_pollc2:
    v_cmp_gt_u32 vcc, 32, v168
    s_nop 1
    s_cmp_eq_u64 vcc, 0
    s_cbranch_scc1 L_polld2
    s_sub_u32 s79, s79, 1
    s_cmp_lg_u32 s79, 0
    s_cbranch_scc1 L_poll2
L_polld2:
    s_mov_b64 exec, -1
    v_mov_b64 v[244:245], v[124:125]
    buffer_load_dwordx4 v[112:115], v237, s[52:55], s5 offen sc1
    s_mov_b64 exec, s[26:27]
    buffer_load_dwordx4 v[124:127], v238, s[52:55], s5 offen offset:1024 sc1
    buffer_load_dwordx4 v[128:131], v238, s[52:55], s5 offen offset:1536 sc1
    s_mov_b64 exec, -1
    s_add_u32 s5, s5, 8192
    buffer_load_dwordx4 v[116:119], v237, s[52:55], s5 offen sc1
    s_mov_b64 exec, s[26:27]
    buffer_load_dwordx4 v[132:135], v238, s[52:55], s5 offen offset:1024 sc1
    buffer_load_dwordx4 v[136:139], v238, s[52:55], s5 offen offset:1536 sc1
    s_mov_b64 exec, -1
    s_add_u32 s5, s5, 8192
    buffer_load_dwordx4 v[120:123], v237, s[52:55], s5 offen sc1
    s_mov_b64 exec, s[26:27]
    buffer_load_dwordx4 v[140:143], v238, s[52:55], s5 offen offset:1024 sc1
    buffer_load_dwordx4 v[144:147], v238, s[52:55], s5 offen offset:1536 sc1
    s_mov_b64 exec, -1
    s_add_u32 s5, s5, 8192
    v_mov_b64 v[148:149], v[244:245]
    v_mov_b64 v[150:151], v[244:245]
    v_mov_b64 v[152:153], v[244:245]
    v_mov_b64 v[154:155], v[244:245]
    v_mov_b64 v[156:157], v[244:245]
    v_mov_b64 v[158:159], v[244:245]
    v_mov_b64 v[160:161], v[244:245]
    v_mov_b64 v[162:163], v[244:245]
    v_mov_b64 v[164:165], v[244:245]
    v_mov_b64 v[166:167], v[244:245]
    v_mov_b64 v[168:169], v[244:245]
    v_mov_b64 v[170:171], v[244:245]
    v_mov_b64 v[172:173], v[244:245]
    v_mov_b64 v[174:175], v[244:245]
    v_mov_b64 v[176:177], v[244:245]
    v_mov_b64 v[178:179], v[244:245]
    v_mov_b64 v[0:1], 0
    v_mov_b64 v[2:3], 0
    v_mov_b64 v[4:5], 0
    v_mov_b64 v[6:7], 0
    v_mov_b64 v[8:9], 0
    v_mov_b64 v[10:11], 0
    v_mov_b64 v[12:13], 0
    v_mov_b64 v[14:15], 0
    v_mov_b64 v[16:17], 0
    v_mov_b64 v[18:19], 0
    v_mov_b64 v[20:21], 0
    v_mov_b64 v[22:23], 0
    v_mov_b64 v[24:25], 0
    v_mov_b64 v[26:27], 0
    v_mov_b64 v[28:29], 0
    v_mov_b64 v[30:31], 0
    v_mov_b64 v[32:33], 0
    v_mov_b64 v[34:35], 0
    v_mov_b64 v[36:37], 0
    v_mov_b64 v[38:39], 0
    v_mov_b64 v[40:41], 0
    v_mov_b64 v[42:43], 0
    v_mov_b64 v[44:45], 0
    v_mov_b64 v[46:47], 0
    v_mov_b64 v[48:49], 0
    v_mov_b64 v[50:51], 0
    v_mov_b64 v[52:53], 0
    v_mov_b64 v[54:55], 0
    v_mov_b64 v[56:57], 0
    v_mov_b64 v[58:59], 0
    v_mov_b64 v[60:61], 0
    v_mov_b64 v[62:63], 0
    s_setprio 2
    s_branch L_ATT
.p2align 12
L_C:
    s_cmpk_ge_u32 s2, 256
    s_cbranch_scc1 L_exit
    s_setprio 1
    s_getpc_b64 s[74:75]
L_pc:
    s_sub_u32 s74, s74, L_pc-recurrent_scan__softmax_full_mha__dense_activation_squared_relu__prompt_kernel
    s_subb_u32 s75, s75, 0
    s_lshr_b32 s73, s2, 3
    s_lshl_b32 s73, s73, 7
    v_bfe_u32 v1, v0, 4, 4
    v_lshl_add_u32 v1, v1, 12, s73
    v_min_u32 v1, L_end-recurrent_scan__softmax_full_mha__dense_activation_squared_relu__prompt_kernel, v1
    s_mov_b32 exec_lo, 0x10001
    s_mov_b32 exec_hi, 0x10001
    global_load_dword v248, v1, s[74:75]
    s_mov_b64 exec, -1
    s_load_dwordx16 s[4:19], s[0:1], 0
    s_load_dwordx4 s[20:23], s[0:1], 64
    s_load_dwordx2 s[24:25], s[0:1], 80
    v_and_b32 v252, 63, v0
    v_bfe_u32 v253, v0, 5, 1
    v_and_b32 v254, 31, v0
    v_bfe_u32 v1, v0, 4, 1
    v_and_b32 v2, 3, v0
    v_lshlrev_b32 v2, 3, v2
    v_lshl_add_u32 v255, v1, 5, v2
    s_and_b32 s69, s68, 3
    s_lshr_b32 s79, s71, 3
    s_and_b32 s71, s71, 7
    s_lshl1_add_u32 s71, s71, s79
    v_bfe_u32 v249, v252, 1, 3
    v_xor_b32 v249, v249, v253
    v_lshlrev_b32 v249, 4, v249
    v_lshl_add_u32 v240, v254, 7, v249
    s_mul_i32 s73, s69, 4128
    v_xor_b32 v240, s73, v240
    v_xor_b32 v241, 32, v240
    v_xor_b32 v242, 64, v240
    v_xor_b32 v243, 0x60, v240
    v_bfe_u32 v249, v252, 2, 2
    v_mad_u32_u24 v249, v253, 8, v249
    v_mul_u32_u24 v249, 128, v249
    v_add_u32 v224, v249, v255
    v_bfe_u32 v249, v252, 3, 1
    v_lshl_add_u32 v224, v249, 6, v224
    v_xor_b32 v228, 64, v224
    s_lshl_b32 s73, s69, 11
    v_add_u32 v224, s73, v224
    v_xor_b32 v225, 2048, v224
    v_xor_b32 v226, 4096, v224
    v_xor_b32 v227, 6144, v224
    v_add_u32 v228, s73, v228
    v_xor_b32 v229, 2048, v228
    v_xor_b32 v230, 4096, v228
    v_xor_b32 v231, 6144, v228
    v_lshrrev_b32 v249, 2, v252
    v_xor_b32 v249, v249, v252
    v_bfe_u32 v249, v249, 2, 1
    v_add_u32 v249, -1, v249
    v_and_b32 v244, 0x3f803f80, v249
    v_mov_b32 v245, v244
    v_mov_b32 v246, v244
    v_mov_b32 v247, v244
    v_bfe_u32 v249, v252, 2, 2
    v_mad_u32_u24 v249, v253, 8, v249
    v_mul_u32_u24 v249, 64, v249
    v_add_u32 v203, v249, v255
    v_mov_b64 v[234:235], 0
    s_lshl_b32 s73, s69, 10
    s_add_u32 s73, s73, 49152
    v_add_u32 v203, s73, v203
    s_lshl_b32 s73, s69, 7
    s_add_u32 s73, s73, 155648
    v_lshl_add_u32 v204, v254, 2, s73
    v_lshl_add_u32 v205, v253, 4, s73
    v_add_u32 v206, -1, v253
    v_and_b32 v249, 3, v252
    v_cmp_eq_u32 vcc, 1, v249
    v_cmp_eq_u32 s[76:77], 2, v249
    v_cmp_eq_u32 s[78:79], 3, v249
    v_lshlrev_b32 v201, 4, v254
    v_add_u32 v201, 157696, v201
    s_lshl_b32 s73, s69, 2
    v_add_u32 v202, s73, v201
    s_add_u32 s73, s73, 160768
    v_mov_b32 v249, s73
    ds_write_b32 v249, v234
    ds_write_b32 v249, v234 offset:16
    s_waitcnt lgkmcnt(0)
    s_mov_b32 s36, s8
    s_mov_b32 s37, s9
    s_mov_b32 s38, 524288
    s_mov_b32 s39, 0x20000
    s_mov_b32 s40, s12
    s_mov_b32 s41, s13
    s_mov_b32 s42, 1409024
    s_mov_b32 s43, 0x20000
    s_mov_b32 s44, s16
    s_mov_b32 s45, s17
    s_mov_b32 s46, 1409024
    s_mov_b32 s47, 0x20000
    s_mov_b32 s48, s20
    s_mov_b32 s49, s21
    s_mov_b32 s50, 2097152
    s_mov_b32 s51, 0x20000
    s_mov_b32 s52, s24
    s_mov_b32 s53, s25
    s_mov_b32 s54, 14680064
    s_mov_b32 s55, 0x20000
    s_mov_b32 s56, s14
    s_mov_b32 s57, s15
    s_mov_b32 s58, 2752
    s_mov_b32 s59, 0x20000
    s_mov_b32 s60, s18
    s_mov_b32 s61, s19
    s_mov_b32 s62, 1024
    s_mov_b32 s63, 0x20000
    s_mov_b32 s64, s22
    s_mov_b32 s65, s23
    s_mov_b32 s66, 256
    s_mov_b32 s67, 0x20000
    s_xor_b32 s10, s71, 2
    s_mul_i32 s10, s10, 3
    s_lshl_b32 s3, s70, 4
    s_add_u32 s3, s3, s71
    s_lshl_b32 s3, s3, 7
    s_add_u32 s3, s3, 11927552
    s_mov_b32 s26, 0xffff
    s_mov_b32 s27, 0xffff
    s_cmp_lg_u32 s69, 0
    s_cbranch_scc1 L_C1
    s_cmp_lg_u32 s70, s71
    s_cbranch_scc1 L_C1
    s_and_b32 s73, s3, 0xfffff800
    v_lshrrev_b32 v1, 2, v252
    v_and_b32 v3, 3, v252
    v_lshlrev_b32 v3, 4, v3
    v_lshl_add_u32 v1, v1, 7, v3
    v_mov_b32 v4, 0
    v_mov_b32 v5, 0
    v_mov_b32 v6, 0
    v_mov_b32 v7, 0
    buffer_store_dwordx4 v[4:7], v1, s[52:55], s73 offen sc1
    s_lshl_b32 s73, s70, 2
    s_waitcnt vmcnt(0)
    s_mov_b64 exec, 1
    v_mov_b32 v3, 1
    buffer_store_dword v3, off, s[64:67], s73 sc1
    s_mov_b64 exec, -1
L_C1:
    s_mov_b32 s34, 1572864
    s_mov_b32 s35, 0x20000
    s_lshr_b32 s75, s70, 2
    s_cmp_eq_u32 s69, 1
    s_cbranch_scc1 L_pf1
    s_cmp_eq_u32 s69, 2
    s_cbranch_scc1 L_pf2
    s_cmp_eq_u32 s69, 3
    s_cbranch_scc1 L_pf3
    s_branch L_pfd
L_pf1:
    s_branch L_pfd
L_pf2:
    s_and_b32 s73, s71, 1
    s_lshl_b32 s74, s75, 1
    s_add_u32 s73, s73, s74
    s_mul_i32 s73, s73, 196608
    s_lshl_b32 s74, s71, 6
    s_add_u32 s73, s73, s74
    v_mul_u32_u24 v1, 3072, v252
    buffer_load_dword v248, v1, s[32:35], s73 offen
    s_branch L_pfd
L_pf3:
L_pfd:
    s_cmp_ge_u32 s69, 2
    s_mov_b64 exec, 0
    s_cbranch_scc1 L_w23
    s_bitcmp1_b32 s69, 0
    s_cbranch_scc1 L_pad1
    s_branch L_pad0
L_w23:
    s_bitcmp1_b32 s69, 0
    s_cbranch_scc1 L_pad3
    s_branch L_pad2
L_wret:
    s_mov_b64 exec, -1
    s_bitcmp1_b32 s71, 0
    s_cbranch_scc1 L_CV
    s_branch L_CK
.p2align 12
L_CK:
    v_and_b32 v251, 0x33, v252
    v_bfe_u32 v249, v252, 2, 1
    v_lshl_add_u32 v251, v249, 3, v251
    v_bfe_u32 v249, v252, 3, 1
    v_lshl_add_u32 v251, v249, 2, v251
    v_lshlrev_b32 v251, 4, v251
    s_barrier
    ds_read_b128 v[0:3], v240 offset:0
    ds_read_b64_tr_b16 v[128:129], v224 offset:16384
    ds_read_b64_tr_b16 v[130:131], v224 offset:16896
    ds_read_b64_tr_b16 v[132:133], v228 offset:16384
    ds_read_b64_tr_b16 v[134:135], v228 offset:16896
    ds_read_b128 v[4:7], v241 offset:0
    ds_read_b64_tr_b16 v[136:137], v225 offset:16384
    ds_read_b64_tr_b16 v[138:139], v225 offset:16896
    ds_read_b64_tr_b16 v[140:141], v229 offset:16384
    ds_read_b64_tr_b16 v[142:143], v229 offset:16896
    ds_read_b128 v[8:11], v242 offset:0
    ds_read_b64_tr_b16 v[144:145], v226 offset:16384
    ds_read_b64_tr_b16 v[146:147], v226 offset:16896
    ds_read_b64_tr_b16 v[148:149], v230 offset:16384
    ds_read_b64_tr_b16 v[150:151], v230 offset:16896
    s_waitcnt lgkmcnt(10)
    v_mfma_f32_32x32x16_bf16 v[160:175], v[128:131], v[0:3], 0
    ds_read_b128 v[12:15], v243 offset:0
    ds_read_b64_tr_b16 v[152:153], v227 offset:16384
    ds_read_b64_tr_b16 v[154:155], v227 offset:16896
    v_mfma_f32_32x32x16_bf16 v[176:191], v[132:135], v[0:3], 0
    ds_read_b64_tr_b16 v[156:157], v231 offset:16384
    ds_read_b64_tr_b16 v[158:159], v231 offset:16896
    s_lshr_b32 s73, s68, 2
    s_lshl_b32 s74, s71, 1
    s_add_u32 s74, s74, s73
    v_mfma_f32_16x16x32_bf16 v[192:195], v[244:247], v[128:131], 0
    v_mfma_f32_16x16x32_bf16 v[196:199], v[244:247], v[132:135], 0
    s_waitcnt lgkmcnt(10)
    v_mfma_f32_32x32x16_bf16 v[160:175], v[136:139], v[4:7], v[160:175]
    s_lshl_b32 s4, s74, 17
    s_lshl_b32 s14, s74, 10
    s_lshl_b32 s74, s69, 11
    s_add_u32 s4, s4, s74
    s_mov_b32 s5, s4
    v_mfma_f32_32x32x16_bf16 v[176:191], v[140:143], v[4:7], v[176:191]
    s_waitcnt lgkmcnt(0)
    s_barrier
    v_mfma_f32_32x32x16_bf16 v[160:175], v[144:147], v[8:11], v[160:175]
    ds_read_b128 v[16:19], v240 offset:24576
    ds_read_b64_tr_b16 v[128:129], v224 offset:40960
    ds_read_b64_tr_b16 v[130:131], v224 offset:41472
    v_mfma_f32_32x32x16_bf16 v[176:191], v[148:151], v[8:11], v[176:191]
    ds_read_b64_tr_b16 v[132:133], v228 offset:40960
    ds_read_b64_tr_b16 v[134:135], v228 offset:41472
    s_lshl_b32 s74, s70, 2
    s_add_u32 s74, s74, s69
    s_lshl_b32 s74, s74, 15
    v_mfma_f32_32x32x16_bf16 v[160:175], v[152:155], v[12:15], v[160:175]
    ds_read_b128 v[20:23], v241 offset:24576
    ds_read_b64_tr_b16 v[136:137], v225 offset:40960
    ds_read_b64_tr_b16 v[138:139], v225 offset:41472
    v_mfma_f32_32x32x16_bf16 v[176:191], v[156:159], v[12:15], v[176:191]
    ds_read_b64_tr_b16 v[140:141], v229 offset:40960
    ds_read_b64_tr_b16 v[142:143], v229 offset:41472
    s_add_u32 s14, s14, s74
    s_add_u32 s14, s14, 9830400
    s_lshr_b32 s73, s68, 1
    v_mfma_f32_16x16x32_bf16 v[208:211], v[244:247], v[0:3], 0
    ds_read_b128 v[24:27], v242 offset:24576
    v_mfma_f32_16x16x32_bf16 v[208:211], v[244:247], v[4:7], v[208:211]
    v_mfma_f32_16x16x32_bf16 v[208:211], v[244:247], v[8:11], v[208:211]
    ds_read_b64_tr_b16 v[144:145], v226 offset:40960
    v_mfma_f32_16x16x32_bf16 v[208:211], v[244:247], v[12:15], v[208:211]
    v_mfma_f32_4x4x4_16b_bf16 v[212:215], v[0:1], v[0:1], 0
    v_mfma_f32_4x4x4_16b_bf16 v[216:219], v[2:3], v[2:3], 0
    ds_read_b64_tr_b16 v[146:147], v226 offset:41472
    v_mfma_f32_4x4x4_16b_bf16 v[212:215], v[4:5], v[4:5], v[212:215]
    v_mfma_f32_4x4x4_16b_bf16 v[216:219], v[6:7], v[6:7], v[216:219]
    ds_read_b64_tr_b16 v[148:149], v230 offset:40960
    v_mfma_f32_4x4x4_16b_bf16 v[212:215], v[8:9], v[8:9], v[212:215]
    v_mfma_f32_4x4x4_16b_bf16 v[216:219], v[10:11], v[10:11], v[216:219]
    ds_read_b64_tr_b16 v[150:151], v230 offset:41472
    v_mfma_f32_4x4x4_16b_bf16 v[212:215], v[12:13], v[12:13], v[212:215]
    v_mfma_f32_4x4x4_16b_bf16 v[216:219], v[14:15], v[14:15], v[216:219]
    s_waitcnt lgkmcnt(10)
    v_mfma_f32_32x32x16_bf16 v[160:175], v[128:131], v[16:19], v[160:175]
    ds_read_b128 v[28:31], v243 offset:24576
    ds_read_b64_tr_b16 v[152:153], v227 offset:40960
    ds_read_b64_tr_b16 v[154:155], v227 offset:41472
    v_mfma_f32_32x32x16_bf16 v[176:191], v[132:135], v[16:19], v[176:191]
    ds_read_b64_tr_b16 v[156:157], v231 offset:40960
    ds_read_b64_tr_b16 v[158:159], v231 offset:41472
    s_mul_i32 s13, s73, 22
    s_lshl_b32 s12, s68, 10
    s_and_b32 s73, s68, 1
    v_mfma_f32_16x16x32_bf16 v[192:195], v[244:247], v[128:131], v[192:195]
    v_mfma_f32_16x16x32_bf16 v[196:199], v[244:247], v[132:135], v[196:199]
    s_waitcnt lgkmcnt(10)
    v_mfma_f32_32x32x16_bf16 v[160:175], v[136:139], v[20:23], v[160:175]
    s_lshl_b32 s7, s13, 1
    s_add_u32 s7, s7, s73
    s_lshl_b32 s7, s7, 13
    s_lshr_b32 s74, s71, 1
    s_lshl_b32 s74, s74, 7
    v_mfma_f32_32x32x16_bf16 v[176:191], v[140:143], v[20:23], v[176:191]
    s_waitcnt lgkmcnt(0)
    s_barrier
    v_mfma_f32_32x32x16_bf16 v[160:175], v[144:147], v[24:27], v[160:175]
    ds_read_b128 v[32:35], v240 offset:49152
    v_add_u32 v224, 65536, v224
    ds_read_b64_tr_b16 v[128:129], v224 offset:0
    ds_read_b64_tr_b16 v[130:131], v224 offset:512
    v_mfma_f32_32x32x16_bf16 v[176:191], v[148:151], v[24:27], v[176:191]
    v_add_u32 v228, 65536, v228
    ds_read_b64_tr_b16 v[132:133], v228 offset:0
    ds_read_b64_tr_b16 v[134:135], v228 offset:512
    s_add_u32 s7, s7, s74
    s_add_u32 s7, s7, 147456
    s_and_b32 s6, s71, 1
    v_mfma_f32_32x32x16_bf16 v[160:175], v[152:155], v[28:31], v[160:175]
    ds_read_b128 v[36:39], v241 offset:49152
    v_add_u32 v225, 65536, v225
    ds_read_b64_tr_b16 v[136:137], v225 offset:0
    ds_read_b64_tr_b16 v[138:139], v225 offset:512
    v_mfma_f32_32x32x16_bf16 v[176:191], v[156:159], v[28:31], v[176:191]
    v_add_u32 v229, 65536, v229
    ds_read_b64_tr_b16 v[140:141], v229 offset:0
    ds_read_b64_tr_b16 v[142:143], v229 offset:512
    s_lshl_b32 s15, s70, 1
    s_add_u32 s15, s15, s6
    s_lshl_b32 s6, s15, 1
    v_mfma_f32_16x16x32_bf16 v[208:211], v[244:247], v[16:19], v[208:211]
    ds_read_b128 v[40:43], v242 offset:49152
    v_mfma_f32_16x16x32_bf16 v[208:211], v[244:247], v[20:23], v[208:211]
    v_mfma_f32_16x16x32_bf16 v[208:211], v[244:247], v[24:27], v[208:211]
    v_add_u32 v226, 65536, v226
    ds_read_b64_tr_b16 v[144:145], v226 offset:0
    v_mfma_f32_16x16x32_bf16 v[208:211], v[244:247], v[28:31], v[208:211]
    v_mfma_f32_4x4x4_16b_bf16 v[212:215], v[16:17], v[16:17], v[212:215]
    v_mfma_f32_4x4x4_16b_bf16 v[216:219], v[18:19], v[18:19], v[216:219]
    ds_read_b64_tr_b16 v[146:147], v226 offset:512
    v_mfma_f32_4x4x4_16b_bf16 v[212:215], v[20:21], v[20:21], v[212:215]
    v_mfma_f32_4x4x4_16b_bf16 v[216:219], v[22:23], v[22:23], v[216:219]
    v_add_u32 v230, 65536, v230
    ds_read_b64_tr_b16 v[148:149], v230 offset:0
    v_mfma_f32_4x4x4_16b_bf16 v[212:215], v[24:25], v[24:25], v[212:215]
    v_mfma_f32_4x4x4_16b_bf16 v[216:219], v[26:27], v[26:27], v[216:219]
    ds_read_b64_tr_b16 v[150:151], v230 offset:512
    v_mfma_f32_4x4x4_16b_bf16 v[212:215], v[28:29], v[28:29], v[212:215]
    v_mfma_f32_4x4x4_16b_bf16 v[216:219], v[30:31], v[30:31], v[216:219]
    s_waitcnt lgkmcnt(10)
    v_mfma_f32_32x32x16_bf16 v[160:175], v[128:131], v[32:35], v[160:175]
    ds_read_b128 v[44:47], v243 offset:49152
    v_add_u32 v227, 65536, v227
    ds_read_b64_tr_b16 v[152:153], v227 offset:0
    ds_read_b64_tr_b16 v[154:155], v227 offset:512
    v_mfma_f32_32x32x16_bf16 v[176:191], v[132:135], v[32:35], v[176:191]
    v_add_u32 v231, 65536, v231
    ds_read_b64_tr_b16 v[156:157], v231 offset:0
    ds_read_b64_tr_b16 v[158:159], v231 offset:512
    s_add_u32 s6, s6, s73
    s_mul_i32 s6, s6, 88064
    s_add_u32 s6, s6, 4194304
    v_mfma_f32_16x16x32_bf16 v[192:195], v[244:247], v[128:131], v[192:195]
    v_mfma_f32_16x16x32_bf16 v[196:199], v[244:247], v[132:135], v[196:199]
    s_waitcnt lgkmcnt(10)
    v_mfma_f32_32x32x16_bf16 v[160:175], v[136:139], v[36:39], v[160:175]
    s_lshl_b32 s15, s15, 3
    s_add_u32 s15, s15, s69
    s_lshl_b32 s15, s15, 13
    s_add_u32 s15, s15, s74
    s_lshr_b32 s16, s71, 1
    v_mfma_f32_32x32x16_bf16 v[176:191], v[140:143], v[36:39], v[176:191]
    s_waitcnt lgkmcnt(0)
    s_barrier
    v_mfma_f32_32x32x16_bf16 v[160:175], v[144:147], v[40:43], v[160:175]
    v_add_u32 v240, 73728, v240
    ds_read_b128 v[48:51], v240 offset:0
    ds_read_b64_tr_b16 v[128:129], v224 offset:24576
    ds_read_b64_tr_b16 v[130:131], v224 offset:25088
    v_mfma_f32_32x32x16_bf16 v[176:191], v[148:151], v[40:43], v[176:191]
    ds_read_b64_tr_b16 v[132:133], v228 offset:24576
    ds_read_b64_tr_b16 v[134:135], v228 offset:25088
    s_and_b32 s73, s70, 3
    s_lshl2_add_u32 s16, s16, s73
    s_lshl2_add_u32 s16, s16, s69
    v_mfma_f32_32x32x16_bf16 v[160:175], v[152:155], v[44:47], v[160:175]
    v_add_u32 v241, 73728, v241
    ds_read_b128 v[52:55], v241 offset:0
    ds_read_b64_tr_b16 v[136:137], v225 offset:24576
    ds_read_b64_tr_b16 v[138:139], v225 offset:25088
    v_mfma_f32_32x32x16_bf16 v[176:191], v[156:159], v[44:47], v[176:191]
    ds_read_b64_tr_b16 v[140:141], v229 offset:24576
    ds_read_b64_tr_b16 v[142:143], v229 offset:25088
    s_lshl_b32 s16, s16, 8
    s_add_u32 s16, s16, 11927552
    s_lshl_b32 s17, s70, 2
    v_mfma_f32_16x16x32_bf16 v[208:211], v[244:247], v[32:35], v[208:211]
    v_add_u32 v242, 73728, v242
    ds_read_b128 v[56:59], v242 offset:0
    v_mfma_f32_16x16x32_bf16 v[208:211], v[244:247], v[36:39], v[208:211]
    v_mfma_f32_16x16x32_bf16 v[208:211], v[244:247], v[40:43], v[208:211]
    ds_read_b64_tr_b16 v[144:145], v226 offset:24576
    v_mfma_f32_16x16x32_bf16 v[208:211], v[244:247], v[44:47], v[208:211]
    v_mfma_f32_4x4x4_16b_bf16 v[212:215], v[32:33], v[32:33], v[212:215]
    v_mfma_f32_4x4x4_16b_bf16 v[216:219], v[34:35], v[34:35], v[216:219]
    ds_read_b64_tr_b16 v[146:147], v226 offset:25088
    v_mfma_f32_4x4x4_16b_bf16 v[212:215], v[36:37], v[36:37], v[212:215]
    v_mfma_f32_4x4x4_16b_bf16 v[216:219], v[38:39], v[38:39], v[216:219]
    ds_read_b64_tr_b16 v[148:149], v230 offset:24576
    v_mfma_f32_4x4x4_16b_bf16 v[212:215], v[40:41], v[40:41], v[212:215]
    v_mfma_f32_4x4x4_16b_bf16 v[216:219], v[42:43], v[42:43], v[216:219]
    ds_read_b64_tr_b16 v[150:151], v230 offset:25088
    v_mfma_f32_4x4x4_16b_bf16 v[212:215], v[44:45], v[44:45], v[212:215]
    v_mfma_f32_4x4x4_16b_bf16 v[216:219], v[46:47], v[46:47], v[216:219]
    s_waitcnt lgkmcnt(10)
    v_mfma_f32_32x32x16_bf16 v[160:175], v[128:131], v[48:51], v[160:175]
    v_add_u32 v243, 73728, v243
    ds_read_b128 v[60:63], v243 offset:0
    ds_read_b64_tr_b16 v[152:153], v227 offset:24576
    ds_read_b64_tr_b16 v[154:155], v227 offset:25088
    v_mfma_f32_32x32x16_bf16 v[176:191], v[132:135], v[48:51], v[176:191]
    ds_read_b64_tr_b16 v[156:157], v231 offset:24576
    ds_read_b64_tr_b16 v[158:159], v231 offset:25088
    s_add_u32 s17, s17, s69
    s_mul_i32 s17, s17, 88064
    s_lshl_b32 s73, s10, 11
    v_mfma_f32_16x16x32_bf16 v[192:195], v[244:247], v[128:131], v[192:195]
    v_mfma_f32_16x16x32_bf16 v[196:199], v[244:247], v[132:135], v[196:199]
    s_waitcnt lgkmcnt(10)
    v_mfma_f32_32x32x16_bf16 v[160:175], v[136:139], v[52:55], v[160:175]
    s_add_u32 s17, s17, s73
    s_add_u32 s17, s17, 4194304
    s_add_u32 s24, s17, 2048
    s_cmp_ge_u32 s10, 43
    s_cselect_b32 s17, 14680064, s17
    v_mfma_f32_32x32x16_bf16 v[176:191], v[140:143], v[52:55], v[176:191]
    s_waitcnt lgkmcnt(0)
    s_barrier
    v_mfma_f32_32x32x16_bf16 v[160:175], v[144:147], v[56:59], v[160:175]
    ds_read_b128 v[64:67], v240 offset:24576
    ds_read_b64_tr_b16 v[128:129], v224 offset:49152
    ds_read_b64_tr_b16 v[130:131], v224 offset:49664
    v_mfma_f32_32x32x16_bf16 v[176:191], v[148:151], v[56:59], v[176:191]
    ds_read_b64_tr_b16 v[132:133], v228 offset:49152
    ds_read_b64_tr_b16 v[134:135], v228 offset:49664
    s_cmp_ge_u32 s10, 42
    s_cselect_b32 s24, 14680064, s24
    s_lshr_b32 s73, s71, 1
    v_mfma_f32_32x32x16_bf16 v[160:175], v[152:155], v[60:63], v[160:175]
    ds_read_b128 v[68:71], v241 offset:24576
    ds_read_b64_tr_b16 v[136:137], v225 offset:49152
    ds_read_b64_tr_b16 v[138:139], v225 offset:49664
    v_mfma_f32_32x32x16_bf16 v[176:191], v[156:159], v[60:63], v[176:191]
    ds_read_b64_tr_b16 v[140:141], v229 offset:49152
    ds_read_b64_tr_b16 v[142:143], v229 offset:49664
    s_lshl_b32 s73, s73, 19
    s_lshl_b32 s74, s70, 2
    s_add_u32 s74, s74, s69
    v_mfma_f32_16x16x32_bf16 v[208:211], v[244:247], v[48:51], v[208:211]
    ds_read_b128 v[72:75], v242 offset:24576
    v_mfma_f32_16x16x32_bf16 v[208:211], v[244:247], v[52:55], v[208:211]
    v_mfma_f32_16x16x32_bf16 v[208:211], v[244:247], v[56:59], v[208:211]
    ds_read_b64_tr_b16 v[144:145], v226 offset:49152
    v_mfma_f32_16x16x32_bf16 v[208:211], v[244:247], v[60:63], v[208:211]
    v_mfma_f32_4x4x4_16b_bf16 v[212:215], v[48:49], v[48:49], v[212:215]
    v_mfma_f32_4x4x4_16b_bf16 v[216:219], v[50:51], v[50:51], v[216:219]
    ds_read_b64_tr_b16 v[146:147], v226 offset:49664
    v_mfma_f32_4x4x4_16b_bf16 v[212:215], v[52:53], v[52:53], v[212:215]
    v_mfma_f32_4x4x4_16b_bf16 v[216:219], v[54:55], v[54:55], v[216:219]
    ds_read_b64_tr_b16 v[148:149], v230 offset:49152
    v_mfma_f32_4x4x4_16b_bf16 v[212:215], v[56:57], v[56:57], v[212:215]
    v_mfma_f32_4x4x4_16b_bf16 v[216:219], v[58:59], v[58:59], v[216:219]
    ds_read_b64_tr_b16 v[150:151], v230 offset:49664
    v_mfma_f32_4x4x4_16b_bf16 v[212:215], v[60:61], v[60:61], v[212:215]
    v_mfma_f32_4x4x4_16b_bf16 v[216:219], v[62:63], v[62:63], v[216:219]
    s_waitcnt lgkmcnt(10)
    v_mfma_f32_32x32x16_bf16 v[160:175], v[128:131], v[64:67], v[160:175]
    ds_read_b128 v[76:79], v243 offset:24576
    ds_read_b64_tr_b16 v[152:153], v227 offset:49152
    ds_read_b64_tr_b16 v[154:155], v227 offset:49664
    v_mfma_f32_32x32x16_bf16 v[176:191], v[132:135], v[64:67], v[176:191]
    ds_read_b64_tr_b16 v[156:157], v231 offset:49152
    ds_read_b64_tr_b16 v[158:159], v231 offset:49664
    s_lshl_b32 s74, s74, 11
    s_add_u32 s75, s73, s74
    s_bitcmp1_b32 s71, 0
    v_mfma_f32_16x16x32_bf16 v[192:195], v[244:247], v[128:131], v[192:195]
    v_mfma_f32_16x16x32_bf16 v[196:199], v[244:247], v[132:135], v[196:199]
    s_waitcnt lgkmcnt(10)
    v_mfma_f32_32x32x16_bf16 v[160:175], v[136:139], v[68:71], v[160:175]
    s_cselect_b32 s73, 1024, 0
    s_add_u32 s75, s75, s73
    s_bitcmp1_b32 s71, 0
    s_mov_b32 s8, 0x20000
    s_cselect_b32 s8, 512, s8
    v_mfma_f32_32x32x16_bf16 v[176:191], v[140:143], v[68:71], v[176:191]
    s_waitcnt lgkmcnt(0)
    s_barrier
    v_mfma_f32_32x32x16_bf16 v[160:175], v[144:147], v[72:75], v[160:175]
    ds_read_b128 v[80:83], v240 offset:49152
    v_add_u32 v224, 73728, v224
    ds_read_b64_tr_b16 v[128:129], v224 offset:0
    ds_read_b64_tr_b16 v[130:131], v224 offset:512
    v_mfma_f32_32x32x16_bf16 v[176:191], v[148:151], v[72:75], v[176:191]
    v_add_u32 v228, 73728, v228
    ds_read_b64_tr_b16 v[132:133], v228 offset:0
    ds_read_b64_tr_b16 v[134:135], v228 offset:512
    s_sub_u32 s9, 0x40000, s8
    s_xor_b32 s20, s69, 0
    s_mul_i32 s20, s20, 3072
    v_mfma_f32_32x32x16_bf16 v[160:175], v[152:155], v[76:79], v[160:175]
    ds_read_b128 v[84:87], v241 offset:49152
    v_add_u32 v225, 73728, v225
    ds_read_b64_tr_b16 v[136:137], v225 offset:0
    ds_read_b64_tr_b16 v[138:139], v225 offset:512
    v_mfma_f32_32x32x16_bf16 v[176:191], v[156:159], v[76:79], v[176:191]
    v_add_u32 v229, 73728, v229
    ds_read_b64_tr_b16 v[140:141], v229 offset:0
    ds_read_b64_tr_b16 v[142:143], v229 offset:512
    s_add_u32 s20, s20, 81920
    s_xor_b32 s21, s69, 1
    s_mul_i32 s21, s21, 3072
    v_mfma_f32_16x16x32_bf16 v[208:211], v[244:247], v[64:67], v[208:211]
    ds_read_b128 v[88:91], v242 offset:49152
    v_mfma_f32_16x16x32_bf16 v[208:211], v[244:247], v[68:71], v[208:211]
    v_mfma_f32_16x16x32_bf16 v[208:211], v[244:247], v[72:75], v[208:211]
    v_add_u32 v226, 73728, v226
    ds_read_b64_tr_b16 v[144:145], v226 offset:0
    v_mfma_f32_16x16x32_bf16 v[208:211], v[244:247], v[76:79], v[208:211]
    v_mfma_f32_4x4x4_16b_bf16 v[212:215], v[64:65], v[64:65], v[212:215]
    v_mfma_f32_4x4x4_16b_bf16 v[216:219], v[66:67], v[66:67], v[216:219]
    ds_read_b64_tr_b16 v[146:147], v226 offset:512
    v_mfma_f32_4x4x4_16b_bf16 v[212:215], v[68:69], v[68:69], v[212:215]
    v_mfma_f32_4x4x4_16b_bf16 v[216:219], v[70:71], v[70:71], v[216:219]
    v_add_u32 v230, 73728, v230
    ds_read_b64_tr_b16 v[148:149], v230 offset:0
    v_mfma_f32_4x4x4_16b_bf16 v[212:215], v[72:73], v[72:73], v[212:215]
    v_mfma_f32_4x4x4_16b_bf16 v[216:219], v[74:75], v[74:75], v[216:219]
    ds_read_b64_tr_b16 v[150:151], v230 offset:512
    v_mfma_f32_4x4x4_16b_bf16 v[212:215], v[76:77], v[76:77], v[212:215]
    v_mfma_f32_4x4x4_16b_bf16 v[216:219], v[78:79], v[78:79], v[216:219]
    s_waitcnt lgkmcnt(10)
    v_mfma_f32_32x32x16_bf16 v[160:175], v[128:131], v[80:83], v[160:175]
    ds_read_b128 v[92:95], v243 offset:49152
    v_add_u32 v227, 73728, v227
    ds_read_b64_tr_b16 v[152:153], v227 offset:0
    ds_read_b64_tr_b16 v[154:155], v227 offset:512
    v_mfma_f32_32x32x16_bf16 v[176:191], v[132:135], v[80:83], v[176:191]
    v_add_u32 v231, 73728, v231
    ds_read_b64_tr_b16 v[156:157], v231 offset:0
    ds_read_b64_tr_b16 v[158:159], v231 offset:512
    s_add_u32 s21, s21, 81920
    s_xor_b32 s22, s69, 2
    s_mul_i32 s22, s22, 3072
    v_mfma_f32_16x16x32_bf16 v[192:195], v[244:247], v[128:131], v[192:195]
    v_mfma_f32_16x16x32_bf16 v[196:199], v[244:247], v[132:135], v[196:199]
    s_waitcnt lgkmcnt(10)
    v_mfma_f32_32x32x16_bf16 v[160:175], v[136:139], v[84:87], v[160:175]
    s_add_u32 s22, s22, 81920
    s_xor_b32 s23, s69, 3
    s_mul_i32 s23, s23, 3072
    s_add_u32 s23, s23, 81920
    v_mfma_f32_32x32x16_bf16 v[176:191], v[140:143], v[84:87], v[176:191]
    s_waitcnt lgkmcnt(0)
    s_barrier
    v_mfma_f32_32x32x16_bf16 v[160:175], v[144:147], v[88:91], v[160:175]
    v_add_u32 v240, 4294893568, v240
    ds_read_b128 v[96:99], v240 offset:0
    v_add_u32 v224, 4294844416, v224
    ds_read_b64_tr_b16 v[128:129], v224 offset:0
    ds_read_b64_tr_b16 v[130:131], v224 offset:512
    v_mfma_f32_32x32x16_bf16 v[176:191], v[148:151], v[88:91], v[176:191]
    v_add_u32 v228, 4294844416, v228
    ds_read_b64_tr_b16 v[132:133], v228 offset:0
    ds_read_b64_tr_b16 v[134:135], v228 offset:512
    v_mfma_f32_32x32x16_bf16 v[160:175], v[152:155], v[92:95], v[160:175]
    v_add_u32 v241, 4294893568, v241
    ds_read_b128 v[100:103], v241 offset:0
    v_add_u32 v225, 4294844416, v225
    ds_read_b64_tr_b16 v[136:137], v225 offset:0
    ds_read_b64_tr_b16 v[138:139], v225 offset:512
    v_mfma_f32_32x32x16_bf16 v[176:191], v[156:159], v[92:95], v[176:191]
    v_add_u32 v229, 4294844416, v229
    ds_read_b64_tr_b16 v[140:141], v229 offset:0
    ds_read_b64_tr_b16 v[142:143], v229 offset:512
    v_mfma_f32_16x16x32_bf16 v[208:211], v[244:247], v[80:83], v[208:211]
    v_add_u32 v242, 4294893568, v242
    ds_read_b128 v[104:107], v242 offset:0
    v_mfma_f32_16x16x32_bf16 v[208:211], v[244:247], v[84:87], v[208:211]
    v_mfma_f32_16x16x32_bf16 v[208:211], v[244:247], v[88:91], v[208:211]
    v_add_u32 v226, 4294844416, v226
    ds_read_b64_tr_b16 v[144:145], v226 offset:0
    v_mfma_f32_16x16x32_bf16 v[208:211], v[244:247], v[92:95], v[208:211]
    v_mfma_f32_4x4x4_16b_bf16 v[212:215], v[80:81], v[80:81], v[212:215]
    v_mfma_f32_4x4x4_16b_bf16 v[216:219], v[82:83], v[82:83], v[216:219]
    ds_read_b64_tr_b16 v[146:147], v226 offset:512
    v_mfma_f32_4x4x4_16b_bf16 v[212:215], v[84:85], v[84:85], v[212:215]
    v_mfma_f32_4x4x4_16b_bf16 v[216:219], v[86:87], v[86:87], v[216:219]
    v_add_u32 v230, 4294844416, v230
    ds_read_b64_tr_b16 v[148:149], v230 offset:0
    v_mfma_f32_4x4x4_16b_bf16 v[212:215], v[88:89], v[88:89], v[212:215]
    v_mfma_f32_4x4x4_16b_bf16 v[216:219], v[90:91], v[90:91], v[216:219]
    ds_read_b64_tr_b16 v[150:151], v230 offset:512
    v_mfma_f32_4x4x4_16b_bf16 v[212:215], v[92:93], v[92:93], v[212:215]
    v_mfma_f32_4x4x4_16b_bf16 v[216:219], v[94:95], v[94:95], v[216:219]
    s_waitcnt lgkmcnt(10)
    v_mfma_f32_32x32x16_bf16 v[160:175], v[128:131], v[96:99], v[160:175]
    v_add_u32 v243, 4294893568, v243
    ds_read_b128 v[108:111], v243 offset:0
    v_add_u32 v227, 4294844416, v227
    ds_read_b64_tr_b16 v[152:153], v227 offset:0
    ds_read_b64_tr_b16 v[154:155], v227 offset:512
    v_mfma_f32_32x32x16_bf16 v[176:191], v[132:135], v[96:99], v[176:191]
    v_add_u32 v231, 4294844416, v231
    ds_read_b64_tr_b16 v[156:157], v231 offset:0
    ds_read_b64_tr_b16 v[158:159], v231 offset:512
    v_mfma_f32_16x16x32_bf16 v[192:195], v[244:247], v[128:131], v[192:195]
    v_mfma_f32_16x16x32_bf16 v[196:199], v[244:247], v[132:135], v[196:199]
    s_waitcnt lgkmcnt(10)
    v_mfma_f32_32x32x16_bf16 v[160:175], v[136:139], v[100:103], v[160:175]
    v_mfma_f32_32x32x16_bf16 v[176:191], v[140:143], v[100:103], v[176:191]
    s_waitcnt lgkmcnt(0)
    s_barrier
    v_mfma_f32_32x32x16_bf16 v[160:175], v[144:147], v[104:107], v[160:175]
    ds_read_b128 v[112:115], v240 offset:24576
    ds_read_b64_tr_b16 v[128:129], v224 offset:24576
    ds_read_b64_tr_b16 v[130:131], v224 offset:25088
    v_mfma_f32_32x32x16_bf16 v[176:191], v[148:151], v[104:107], v[176:191]
    ds_read_b64_tr_b16 v[132:133], v228 offset:24576
    ds_read_b64_tr_b16 v[134:135], v228 offset:25088
    v_mfma_f32_32x32x16_bf16 v[160:175], v[152:155], v[108:111], v[160:175]
    ds_read_b128 v[116:119], v241 offset:24576
    ds_read_b64_tr_b16 v[136:137], v225 offset:24576
    ds_read_b64_tr_b16 v[138:139], v225 offset:25088
    v_mfma_f32_32x32x16_bf16 v[176:191], v[156:159], v[108:111], v[176:191]
    ds_read_b64_tr_b16 v[140:141], v229 offset:24576
    ds_read_b64_tr_b16 v[142:143], v229 offset:25088
    v_mfma_f32_16x16x32_bf16 v[208:211], v[244:247], v[96:99], v[208:211]
    ds_read_b128 v[120:123], v242 offset:24576
    v_mfma_f32_16x16x32_bf16 v[208:211], v[244:247], v[100:103], v[208:211]
    v_mfma_f32_16x16x32_bf16 v[208:211], v[244:247], v[104:107], v[208:211]
    ds_read_b64_tr_b16 v[144:145], v226 offset:24576
    v_mfma_f32_16x16x32_bf16 v[208:211], v[244:247], v[108:111], v[208:211]
    v_mfma_f32_4x4x4_16b_bf16 v[212:215], v[96:97], v[96:97], v[212:215]
    v_mfma_f32_4x4x4_16b_bf16 v[216:219], v[98:99], v[98:99], v[216:219]
    ds_read_b64_tr_b16 v[146:147], v226 offset:25088
    v_mfma_f32_4x4x4_16b_bf16 v[212:215], v[100:101], v[100:101], v[212:215]
    v_mfma_f32_4x4x4_16b_bf16 v[216:219], v[102:103], v[102:103], v[216:219]
    ds_read_b64_tr_b16 v[148:149], v230 offset:24576
    v_mfma_f32_4x4x4_16b_bf16 v[212:215], v[104:105], v[104:105], v[212:215]
    v_mfma_f32_4x4x4_16b_bf16 v[216:219], v[106:107], v[106:107], v[216:219]
    ds_read_b64_tr_b16 v[150:151], v230 offset:25088
    v_mfma_f32_4x4x4_16b_bf16 v[212:215], v[108:109], v[108:109], v[212:215]
    v_mfma_f32_4x4x4_16b_bf16 v[216:219], v[110:111], v[110:111], v[216:219]
    s_waitcnt lgkmcnt(10)
    v_mfma_f32_32x32x16_bf16 v[160:175], v[128:131], v[112:115], v[160:175]
    ds_read_b128 v[124:127], v243 offset:24576
    ds_read_b64_tr_b16 v[152:153], v227 offset:24576
    ds_read_b64_tr_b16 v[154:155], v227 offset:25088
    v_mfma_f32_32x32x16_bf16 v[176:191], v[132:135], v[112:115], v[176:191]
    ds_read_b64_tr_b16 v[156:157], v231 offset:24576
    ds_read_b64_tr_b16 v[158:159], v231 offset:25088
    v_mfma_f32_16x16x32_bf16 v[192:195], v[244:247], v[128:131], v[192:195]
    v_mfma_f32_16x16x32_bf16 v[196:199], v[244:247], v[132:135], v[196:199]
    s_waitcnt lgkmcnt(10)
    v_mfma_f32_16x16x32_bf16 v[208:211], v[244:247], v[112:115], v[208:211]
    v_mfma_f32_16x16x32_bf16 v[208:211], v[244:247], v[116:119], v[208:211]
    s_waitcnt lgkmcnt(0)
    v_mfma_f32_16x16x32_bf16 v[208:211], v[244:247], v[120:123], v[208:211]
    v_mfma_f32_16x16x32_bf16 v[208:211], v[244:247], v[124:127], v[208:211]
    v_mfma_f32_4x4x4_16b_bf16 v[212:215], v[112:113], v[112:113], v[212:215]
    v_mfma_f32_4x4x4_16b_bf16 v[216:219], v[114:115], v[114:115], v[216:219]
    s_nop 0
    v_mfma_f32_4x4x4_16b_bf16 v[212:215], v[116:117], v[116:117], v[212:215]
    v_mfma_f32_4x4x4_16b_bf16 v[216:219], v[118:119], v[118:119], v[216:219]
    ds_write_b32 v202, v192 offset:0
    v_mfma_f32_4x4x4_16b_bf16 v[212:215], v[120:121], v[120:121], v[212:215]
    v_mfma_f32_4x4x4_16b_bf16 v[216:219], v[122:123], v[122:123], v[216:219]
    ds_write_b32 v202, v196 offset:512
    v_mfma_f32_4x4x4_16b_bf16 v[212:215], v[124:125], v[124:125], v[212:215]
    v_mfma_f32_4x4x4_16b_bf16 v[216:219], v[126:127], v[126:127], v[216:219]
    v_mfma_f32_32x32x16_bf16 v[160:175], v[136:139], v[116:119], v[160:175]
    v_mov_b32 v240, v203
    v_xor_b32 v241, 1024, v203
    v_xor_b32 v242, 2048, v203
    v_xor_b32 v243, 3072, v203
    s_waitcnt lgkmcnt(0)
    s_barrier
    v_mfma_f32_32x32x16_bf16 v[176:191], v[140:143], v[116:119], v[176:191]
    ds_read_b128 v[192:195], v201
    ds_read_b128 v[196:199], v201 offset:512
    ds_read_b64_tr_b16 v[128:129], v240 offset:0
    ds_read_b64_tr_b16 v[130:131], v240 offset:256
    v_add_f32 v212, v212, v216
    v_add_f32 v213, v213, v217
    v_mfma_f32_32x32x16_bf16 v[160:175], v[144:147], v[120:123], v[160:175]
    ds_read_b64_tr_b16 v[132:133], v241 offset:0
    ds_read_b64_tr_b16 v[134:135], v241 offset:256
    v_add_f32 v214, v214, v218
    v_add_f32 v215, v215, v219
    v_cndmask_b32 v249, v212, v213, vcc
    v_cndmask_b32 v249, v249, v214, s[76:77]
    v_mfma_f32_32x32x16_bf16 v[176:191], v[148:151], v[120:123], v[176:191]
    ds_read_b64_tr_b16 v[136:137], v242 offset:0
    ds_read_b64_tr_b16 v[138:139], v242 offset:256
    v_cndmask_b32 v249, v249, v215, s[78:79]
    v_mov_b32 v250, v249
    v_mul_f32 v200, 0x3b000000, v208
    v_cvt_pk_bf16_f32 v224, -v200, -v200
    v_mfma_f32_32x32x16_bf16 v[160:175], v[152:155], v[124:127], v[160:175]
    ds_read_b64_tr_b16 v[140:141], v243 offset:0
    ds_read_b64_tr_b16 v[142:143], v243 offset:256
    v_permlane32_swap_b32 v249, v250
    v_add_f32 v249, v249, v250
    v_mul_f32 v249, 0x3b000000, v249
    v_fma_f32 v249, -v200, v200, v249
    v_mfma_f32_32x32x16_bf16 v[176:191], v[156:159], v[124:127], v[176:191]
    ds_read_b64_tr_b16 v[144:145], v240 offset:4096
    ds_read_b64_tr_b16 v[146:147], v240 offset:4352
    v_max_f32 v249, 0, v249
    v_cvt_pk_bf16_f32 v249, v249, v249
    v_lshlrev_b32 v249, 16, v249
    v_add_f32 v249, 0x3727c5ac, v249
    ds_read_b64_tr_b16 v[148:149], v241 offset:4096
    ds_read_b64_tr_b16 v[150:151], v241 offset:4352
    s_branch L_C2
.p2align 12
L_CV:
    v_bfe_u32 v249, v252, 4, 1
    v_lshlrev_b32 v249, 17, v249
    v_lshl_add_u32 v249, v253, 8, v249
    v_and_b32 v251, 15, v252
    v_lshl_add_u32 v251, v251, 4, v249
    s_barrier
    ds_read_b128 v[0:3], v240 offset:0
    ds_read_b64_tr_b16 v[128:129], v224 offset:16384
    ds_read_b64_tr_b16 v[130:131], v224 offset:16896
    ds_read_b64_tr_b16 v[132:133], v228 offset:16384
    ds_read_b64_tr_b16 v[134:135], v228 offset:16896
    ds_read_b128 v[4:7], v241 offset:0
    ds_read_b64_tr_b16 v[136:137], v225 offset:16384
    ds_read_b64_tr_b16 v[138:139], v225 offset:16896
    ds_read_b64_tr_b16 v[140:141], v229 offset:16384
    ds_read_b64_tr_b16 v[142:143], v229 offset:16896
    ds_read_b128 v[8:11], v242 offset:0
    ds_read_b64_tr_b16 v[144:145], v226 offset:16384
    ds_read_b64_tr_b16 v[146:147], v226 offset:16896
    ds_read_b64_tr_b16 v[148:149], v230 offset:16384
    ds_read_b64_tr_b16 v[150:151], v230 offset:16896
    s_waitcnt lgkmcnt(10)
    v_mfma_f32_32x32x16_bf16 v[160:175], v[0:3], v[128:131], 0
    ds_read_b128 v[12:15], v243 offset:0
    ds_read_b64_tr_b16 v[152:153], v227 offset:16384
    ds_read_b64_tr_b16 v[154:155], v227 offset:16896
    v_mfma_f32_32x32x16_bf16 v[176:191], v[0:3], v[132:135], 0
    ds_read_b64_tr_b16 v[156:157], v231 offset:16384
    ds_read_b64_tr_b16 v[158:159], v231 offset:16896
    s_lshr_b32 s73, s68, 2
    s_lshl_b32 s74, s71, 1
    s_add_u32 s74, s74, s73
    v_mfma_f32_16x16x32_bf16 v[192:195], v[244:247], v[128:131], 0
    v_mfma_f32_16x16x32_bf16 v[196:199], v[244:247], v[132:135], 0
    s_waitcnt lgkmcnt(10)
    v_mfma_f32_32x32x16_bf16 v[160:175], v[4:7], v[136:139], v[160:175]
    s_lshl_b32 s4, s74, 17
    s_lshl_b32 s14, s74, 10
    s_lshl_b32 s74, s69, 11
    s_add_u32 s4, s4, s74
    s_mov_b32 s5, s4
    v_mfma_f32_32x32x16_bf16 v[176:191], v[4:7], v[140:143], v[176:191]
    s_waitcnt lgkmcnt(0)
    s_barrier
    v_mfma_f32_32x32x16_bf16 v[160:175], v[8:11], v[144:147], v[160:175]
    ds_read_b128 v[16:19], v240 offset:24576
    ds_read_b64_tr_b16 v[128:129], v224 offset:40960
    ds_read_b64_tr_b16 v[130:131], v224 offset:41472
    v_mfma_f32_32x32x16_bf16 v[176:191], v[8:11], v[148:151], v[176:191]
    ds_read_b64_tr_b16 v[132:133], v228 offset:40960
    ds_read_b64_tr_b16 v[134:135], v228 offset:41472
    s_lshl_b32 s74, s70, 2
    s_add_u32 s74, s74, s69
    s_lshl_b32 s74, s74, 15
    v_mfma_f32_32x32x16_bf16 v[160:175], v[12:15], v[152:155], v[160:175]
    ds_read_b128 v[20:23], v241 offset:24576
    ds_read_b64_tr_b16 v[136:137], v225 offset:40960
    ds_read_b64_tr_b16 v[138:139], v225 offset:41472
    v_mfma_f32_32x32x16_bf16 v[176:191], v[12:15], v[156:159], v[176:191]
    ds_read_b64_tr_b16 v[140:141], v229 offset:40960
    ds_read_b64_tr_b16 v[142:143], v229 offset:41472
    s_add_u32 s14, s14, s74
    s_add_u32 s14, s14, 9830400
    s_lshr_b32 s73, s68, 1
    v_mfma_f32_16x16x32_bf16 v[208:211], v[244:247], v[0:3], 0
    ds_read_b128 v[24:27], v242 offset:24576
    v_mfma_f32_16x16x32_bf16 v[208:211], v[244:247], v[4:7], v[208:211]
    v_mfma_f32_16x16x32_bf16 v[208:211], v[244:247], v[8:11], v[208:211]
    ds_read_b64_tr_b16 v[144:145], v226 offset:40960
    v_mfma_f32_16x16x32_bf16 v[208:211], v[244:247], v[12:15], v[208:211]
    v_mfma_f32_4x4x4_16b_bf16 v[212:215], v[0:1], v[0:1], 0
    v_mfma_f32_4x4x4_16b_bf16 v[216:219], v[2:3], v[2:3], 0
    ds_read_b64_tr_b16 v[146:147], v226 offset:41472
    v_mfma_f32_4x4x4_16b_bf16 v[212:215], v[4:5], v[4:5], v[212:215]
    v_mfma_f32_4x4x4_16b_bf16 v[216:219], v[6:7], v[6:7], v[216:219]
    ds_read_b64_tr_b16 v[148:149], v230 offset:40960
    v_mfma_f32_4x4x4_16b_bf16 v[212:215], v[8:9], v[8:9], v[212:215]
    v_mfma_f32_4x4x4_16b_bf16 v[216:219], v[10:11], v[10:11], v[216:219]
    ds_read_b64_tr_b16 v[150:151], v230 offset:41472
    v_mfma_f32_4x4x4_16b_bf16 v[212:215], v[12:13], v[12:13], v[212:215]
    v_mfma_f32_4x4x4_16b_bf16 v[216:219], v[14:15], v[14:15], v[216:219]
    s_waitcnt lgkmcnt(10)
    v_mfma_f32_32x32x16_bf16 v[160:175], v[16:19], v[128:131], v[160:175]
    ds_read_b128 v[28:31], v243 offset:24576
    ds_read_b64_tr_b16 v[152:153], v227 offset:40960
    ds_read_b64_tr_b16 v[154:155], v227 offset:41472
    v_mfma_f32_32x32x16_bf16 v[176:191], v[16:19], v[132:135], v[176:191]
    ds_read_b64_tr_b16 v[156:157], v231 offset:40960
    ds_read_b64_tr_b16 v[158:159], v231 offset:41472
    s_mul_i32 s13, s73, 22
    s_lshl_b32 s12, s68, 10
    s_and_b32 s73, s68, 1
    v_mfma_f32_16x16x32_bf16 v[192:195], v[244:247], v[128:131], v[192:195]
    v_mfma_f32_16x16x32_bf16 v[196:199], v[244:247], v[132:135], v[196:199]
    s_waitcnt lgkmcnt(10)
    v_mfma_f32_32x32x16_bf16 v[160:175], v[20:23], v[136:139], v[160:175]
    s_lshl_b32 s7, s13, 1
    s_add_u32 s7, s7, s73
    s_lshl_b32 s7, s7, 13
    s_lshr_b32 s74, s71, 1
    s_lshl_b32 s74, s74, 7
    v_mfma_f32_32x32x16_bf16 v[176:191], v[20:23], v[140:143], v[176:191]
    s_waitcnt lgkmcnt(0)
    s_barrier
    v_mfma_f32_32x32x16_bf16 v[160:175], v[24:27], v[144:147], v[160:175]
    ds_read_b128 v[32:35], v240 offset:49152
    v_add_u32 v224, 65536, v224
    ds_read_b64_tr_b16 v[128:129], v224 offset:0
    ds_read_b64_tr_b16 v[130:131], v224 offset:512
    v_mfma_f32_32x32x16_bf16 v[176:191], v[24:27], v[148:151], v[176:191]
    v_add_u32 v228, 65536, v228
    ds_read_b64_tr_b16 v[132:133], v228 offset:0
    ds_read_b64_tr_b16 v[134:135], v228 offset:512
    s_add_u32 s7, s7, s74
    s_add_u32 s7, s7, 147456
    s_and_b32 s6, s71, 1
    v_mfma_f32_32x32x16_bf16 v[160:175], v[28:31], v[152:155], v[160:175]
    ds_read_b128 v[36:39], v241 offset:49152
    v_add_u32 v225, 65536, v225
    ds_read_b64_tr_b16 v[136:137], v225 offset:0
    ds_read_b64_tr_b16 v[138:139], v225 offset:512
    v_mfma_f32_32x32x16_bf16 v[176:191], v[28:31], v[156:159], v[176:191]
    v_add_u32 v229, 65536, v229
    ds_read_b64_tr_b16 v[140:141], v229 offset:0
    ds_read_b64_tr_b16 v[142:143], v229 offset:512
    s_lshl_b32 s15, s70, 1
    s_add_u32 s15, s15, s6
    s_lshl_b32 s6, s15, 1
    v_mfma_f32_16x16x32_bf16 v[208:211], v[244:247], v[16:19], v[208:211]
    ds_read_b128 v[40:43], v242 offset:49152
    v_mfma_f32_16x16x32_bf16 v[208:211], v[244:247], v[20:23], v[208:211]
    v_mfma_f32_16x16x32_bf16 v[208:211], v[244:247], v[24:27], v[208:211]
    v_add_u32 v226, 65536, v226
    ds_read_b64_tr_b16 v[144:145], v226 offset:0
    v_mfma_f32_16x16x32_bf16 v[208:211], v[244:247], v[28:31], v[208:211]
    v_mfma_f32_4x4x4_16b_bf16 v[212:215], v[16:17], v[16:17], v[212:215]
    v_mfma_f32_4x4x4_16b_bf16 v[216:219], v[18:19], v[18:19], v[216:219]
    ds_read_b64_tr_b16 v[146:147], v226 offset:512
    v_mfma_f32_4x4x4_16b_bf16 v[212:215], v[20:21], v[20:21], v[212:215]
    v_mfma_f32_4x4x4_16b_bf16 v[216:219], v[22:23], v[22:23], v[216:219]
    v_add_u32 v230, 65536, v230
    ds_read_b64_tr_b16 v[148:149], v230 offset:0
    v_mfma_f32_4x4x4_16b_bf16 v[212:215], v[24:25], v[24:25], v[212:215]
    v_mfma_f32_4x4x4_16b_bf16 v[216:219], v[26:27], v[26:27], v[216:219]
    ds_read_b64_tr_b16 v[150:151], v230 offset:512
    v_mfma_f32_4x4x4_16b_bf16 v[212:215], v[28:29], v[28:29], v[212:215]
    v_mfma_f32_4x4x4_16b_bf16 v[216:219], v[30:31], v[30:31], v[216:219]
    s_waitcnt lgkmcnt(10)
    v_mfma_f32_32x32x16_bf16 v[160:175], v[32:35], v[128:131], v[160:175]
    ds_read_b128 v[44:47], v243 offset:49152
    v_add_u32 v227, 65536, v227
    ds_read_b64_tr_b16 v[152:153], v227 offset:0
    ds_read_b64_tr_b16 v[154:155], v227 offset:512
    v_mfma_f32_32x32x16_bf16 v[176:191], v[32:35], v[132:135], v[176:191]
    v_add_u32 v231, 65536, v231
    ds_read_b64_tr_b16 v[156:157], v231 offset:0
    ds_read_b64_tr_b16 v[158:159], v231 offset:512
    s_add_u32 s6, s6, s73
    s_mul_i32 s6, s6, 88064
    s_add_u32 s6, s6, 4194304
    v_mfma_f32_16x16x32_bf16 v[192:195], v[244:247], v[128:131], v[192:195]
    v_mfma_f32_16x16x32_bf16 v[196:199], v[244:247], v[132:135], v[196:199]
    s_waitcnt lgkmcnt(10)
    v_mfma_f32_32x32x16_bf16 v[160:175], v[36:39], v[136:139], v[160:175]
    s_lshl_b32 s15, s15, 3
    s_add_u32 s15, s15, s69
    s_lshl_b32 s15, s15, 13
    s_add_u32 s15, s15, s74
    s_lshr_b32 s16, s71, 1
    v_mfma_f32_32x32x16_bf16 v[176:191], v[36:39], v[140:143], v[176:191]
    s_waitcnt lgkmcnt(0)
    s_barrier
    v_mfma_f32_32x32x16_bf16 v[160:175], v[40:43], v[144:147], v[160:175]
    v_add_u32 v240, 73728, v240
    ds_read_b128 v[48:51], v240 offset:0
    ds_read_b64_tr_b16 v[128:129], v224 offset:24576
    ds_read_b64_tr_b16 v[130:131], v224 offset:25088
    v_mfma_f32_32x32x16_bf16 v[176:191], v[40:43], v[148:151], v[176:191]
    ds_read_b64_tr_b16 v[132:133], v228 offset:24576
    ds_read_b64_tr_b16 v[134:135], v228 offset:25088
    s_and_b32 s73, s70, 3
    s_lshl2_add_u32 s16, s16, s73
    s_lshl2_add_u32 s16, s16, s69
    v_mfma_f32_32x32x16_bf16 v[160:175], v[44:47], v[152:155], v[160:175]
    v_add_u32 v241, 73728, v241
    ds_read_b128 v[52:55], v241 offset:0
    ds_read_b64_tr_b16 v[136:137], v225 offset:24576
    ds_read_b64_tr_b16 v[138:139], v225 offset:25088
    v_mfma_f32_32x32x16_bf16 v[176:191], v[44:47], v[156:159], v[176:191]
    ds_read_b64_tr_b16 v[140:141], v229 offset:24576
    ds_read_b64_tr_b16 v[142:143], v229 offset:25088
    s_lshl_b32 s16, s16, 8
    s_add_u32 s16, s16, 11927552
    s_lshl_b32 s17, s70, 2
    v_mfma_f32_16x16x32_bf16 v[208:211], v[244:247], v[32:35], v[208:211]
    v_add_u32 v242, 73728, v242
    ds_read_b128 v[56:59], v242 offset:0
    v_mfma_f32_16x16x32_bf16 v[208:211], v[244:247], v[36:39], v[208:211]
    v_mfma_f32_16x16x32_bf16 v[208:211], v[244:247], v[40:43], v[208:211]
    ds_read_b64_tr_b16 v[144:145], v226 offset:24576
    v_mfma_f32_16x16x32_bf16 v[208:211], v[244:247], v[44:47], v[208:211]
    v_mfma_f32_4x4x4_16b_bf16 v[212:215], v[32:33], v[32:33], v[212:215]
    v_mfma_f32_4x4x4_16b_bf16 v[216:219], v[34:35], v[34:35], v[216:219]
    ds_read_b64_tr_b16 v[146:147], v226 offset:25088
    v_mfma_f32_4x4x4_16b_bf16 v[212:215], v[36:37], v[36:37], v[212:215]
    v_mfma_f32_4x4x4_16b_bf16 v[216:219], v[38:39], v[38:39], v[216:219]
    ds_read_b64_tr_b16 v[148:149], v230 offset:24576
    v_mfma_f32_4x4x4_16b_bf16 v[212:215], v[40:41], v[40:41], v[212:215]
    v_mfma_f32_4x4x4_16b_bf16 v[216:219], v[42:43], v[42:43], v[216:219]
    ds_read_b64_tr_b16 v[150:151], v230 offset:25088
    v_mfma_f32_4x4x4_16b_bf16 v[212:215], v[44:45], v[44:45], v[212:215]
    v_mfma_f32_4x4x4_16b_bf16 v[216:219], v[46:47], v[46:47], v[216:219]
    s_waitcnt lgkmcnt(10)
    v_mfma_f32_32x32x16_bf16 v[160:175], v[48:51], v[128:131], v[160:175]
    v_add_u32 v243, 73728, v243
    ds_read_b128 v[60:63], v243 offset:0
    ds_read_b64_tr_b16 v[152:153], v227 offset:24576
    ds_read_b64_tr_b16 v[154:155], v227 offset:25088
    v_mfma_f32_32x32x16_bf16 v[176:191], v[48:51], v[132:135], v[176:191]
    ds_read_b64_tr_b16 v[156:157], v231 offset:24576
    ds_read_b64_tr_b16 v[158:159], v231 offset:25088
    s_add_u32 s17, s17, s69
    s_mul_i32 s17, s17, 88064
    s_lshl_b32 s73, s10, 11
    v_mfma_f32_16x16x32_bf16 v[192:195], v[244:247], v[128:131], v[192:195]
    v_mfma_f32_16x16x32_bf16 v[196:199], v[244:247], v[132:135], v[196:199]
    s_waitcnt lgkmcnt(10)
    v_mfma_f32_32x32x16_bf16 v[160:175], v[52:55], v[136:139], v[160:175]
    s_add_u32 s17, s17, s73
    s_add_u32 s17, s17, 4194304
    s_add_u32 s24, s17, 2048
    s_cmp_ge_u32 s10, 43
    s_cselect_b32 s17, 14680064, s17
    v_mfma_f32_32x32x16_bf16 v[176:191], v[52:55], v[140:143], v[176:191]
    s_waitcnt lgkmcnt(0)
    s_barrier
    v_mfma_f32_32x32x16_bf16 v[160:175], v[56:59], v[144:147], v[160:175]
    ds_read_b128 v[64:67], v240 offset:24576
    ds_read_b64_tr_b16 v[128:129], v224 offset:49152
    ds_read_b64_tr_b16 v[130:131], v224 offset:49664
    v_mfma_f32_32x32x16_bf16 v[176:191], v[56:59], v[148:151], v[176:191]
    ds_read_b64_tr_b16 v[132:133], v228 offset:49152
    ds_read_b64_tr_b16 v[134:135], v228 offset:49664
    s_cmp_ge_u32 s10, 42
    s_cselect_b32 s24, 14680064, s24
    s_lshr_b32 s73, s71, 1
    v_mfma_f32_32x32x16_bf16 v[160:175], v[60:63], v[152:155], v[160:175]
    ds_read_b128 v[68:71], v241 offset:24576
    ds_read_b64_tr_b16 v[136:137], v225 offset:49152
    ds_read_b64_tr_b16 v[138:139], v225 offset:49664
    v_mfma_f32_32x32x16_bf16 v[176:191], v[60:63], v[156:159], v[176:191]
    ds_read_b64_tr_b16 v[140:141], v229 offset:49152
    ds_read_b64_tr_b16 v[142:143], v229 offset:49664
    s_lshl_b32 s73, s73, 19
    s_lshl_b32 s74, s70, 2
    s_add_u32 s74, s74, s69
    v_mfma_f32_16x16x32_bf16 v[208:211], v[244:247], v[48:51], v[208:211]
    ds_read_b128 v[72:75], v242 offset:24576
    v_mfma_f32_16x16x32_bf16 v[208:211], v[244:247], v[52:55], v[208:211]
    v_mfma_f32_16x16x32_bf16 v[208:211], v[244:247], v[56:59], v[208:211]
    ds_read_b64_tr_b16 v[144:145], v226 offset:49152
    v_mfma_f32_16x16x32_bf16 v[208:211], v[244:247], v[60:63], v[208:211]
    v_mfma_f32_4x4x4_16b_bf16 v[212:215], v[48:49], v[48:49], v[212:215]
    v_mfma_f32_4x4x4_16b_bf16 v[216:219], v[50:51], v[50:51], v[216:219]
    ds_read_b64_tr_b16 v[146:147], v226 offset:49664
    v_mfma_f32_4x4x4_16b_bf16 v[212:215], v[52:53], v[52:53], v[212:215]
    v_mfma_f32_4x4x4_16b_bf16 v[216:219], v[54:55], v[54:55], v[216:219]
    ds_read_b64_tr_b16 v[148:149], v230 offset:49152
    v_mfma_f32_4x4x4_16b_bf16 v[212:215], v[56:57], v[56:57], v[212:215]
    v_mfma_f32_4x4x4_16b_bf16 v[216:219], v[58:59], v[58:59], v[216:219]
    ds_read_b64_tr_b16 v[150:151], v230 offset:49664
    v_mfma_f32_4x4x4_16b_bf16 v[212:215], v[60:61], v[60:61], v[212:215]
    v_mfma_f32_4x4x4_16b_bf16 v[216:219], v[62:63], v[62:63], v[216:219]
    s_waitcnt lgkmcnt(10)
    v_mfma_f32_32x32x16_bf16 v[160:175], v[64:67], v[128:131], v[160:175]
    ds_read_b128 v[76:79], v243 offset:24576
    ds_read_b64_tr_b16 v[152:153], v227 offset:49152
    ds_read_b64_tr_b16 v[154:155], v227 offset:49664
    v_mfma_f32_32x32x16_bf16 v[176:191], v[64:67], v[132:135], v[176:191]
    ds_read_b64_tr_b16 v[156:157], v231 offset:49152
    ds_read_b64_tr_b16 v[158:159], v231 offset:49664
    s_lshl_b32 s74, s74, 11
    s_add_u32 s75, s73, s74
    s_bitcmp1_b32 s71, 0
    v_mfma_f32_16x16x32_bf16 v[192:195], v[244:247], v[128:131], v[192:195]
    v_mfma_f32_16x16x32_bf16 v[196:199], v[244:247], v[132:135], v[196:199]
    s_waitcnt lgkmcnt(10)
    v_mfma_f32_32x32x16_bf16 v[160:175], v[68:71], v[136:139], v[160:175]
    s_cselect_b32 s73, 1024, 0
    s_add_u32 s75, s75, s73
    s_bitcmp1_b32 s71, 0
    s_mov_b32 s8, 0x20000
    s_cselect_b32 s8, 512, s8
    v_mfma_f32_32x32x16_bf16 v[176:191], v[68:71], v[140:143], v[176:191]
    s_waitcnt lgkmcnt(0)
    s_barrier
    v_mfma_f32_32x32x16_bf16 v[160:175], v[72:75], v[144:147], v[160:175]
    ds_read_b128 v[80:83], v240 offset:49152
    v_add_u32 v224, 73728, v224
    ds_read_b64_tr_b16 v[128:129], v224 offset:0
    ds_read_b64_tr_b16 v[130:131], v224 offset:512
    v_mfma_f32_32x32x16_bf16 v[176:191], v[72:75], v[148:151], v[176:191]
    v_add_u32 v228, 73728, v228
    ds_read_b64_tr_b16 v[132:133], v228 offset:0
    ds_read_b64_tr_b16 v[134:135], v228 offset:512
    s_sub_u32 s9, 0x40000, s8
    s_xor_b32 s20, s69, 0
    s_mul_i32 s20, s20, 3072
    v_mfma_f32_32x32x16_bf16 v[160:175], v[76:79], v[152:155], v[160:175]
    ds_read_b128 v[84:87], v241 offset:49152
    v_add_u32 v225, 73728, v225
    ds_read_b64_tr_b16 v[136:137], v225 offset:0
    ds_read_b64_tr_b16 v[138:139], v225 offset:512
    v_mfma_f32_32x32x16_bf16 v[176:191], v[76:79], v[156:159], v[176:191]
    v_add_u32 v229, 73728, v229
    ds_read_b64_tr_b16 v[140:141], v229 offset:0
    ds_read_b64_tr_b16 v[142:143], v229 offset:512
    s_add_u32 s20, s20, 81920
    s_xor_b32 s21, s69, 1
    s_mul_i32 s21, s21, 3072
    v_mfma_f32_16x16x32_bf16 v[208:211], v[244:247], v[64:67], v[208:211]
    ds_read_b128 v[88:91], v242 offset:49152
    v_mfma_f32_16x16x32_bf16 v[208:211], v[244:247], v[68:71], v[208:211]
    v_mfma_f32_16x16x32_bf16 v[208:211], v[244:247], v[72:75], v[208:211]
    v_add_u32 v226, 73728, v226
    ds_read_b64_tr_b16 v[144:145], v226 offset:0
    v_mfma_f32_16x16x32_bf16 v[208:211], v[244:247], v[76:79], v[208:211]
    v_mfma_f32_4x4x4_16b_bf16 v[212:215], v[64:65], v[64:65], v[212:215]
    v_mfma_f32_4x4x4_16b_bf16 v[216:219], v[66:67], v[66:67], v[216:219]
    ds_read_b64_tr_b16 v[146:147], v226 offset:512
    v_mfma_f32_4x4x4_16b_bf16 v[212:215], v[68:69], v[68:69], v[212:215]
    v_mfma_f32_4x4x4_16b_bf16 v[216:219], v[70:71], v[70:71], v[216:219]
    v_add_u32 v230, 73728, v230
    ds_read_b64_tr_b16 v[148:149], v230 offset:0
    v_mfma_f32_4x4x4_16b_bf16 v[212:215], v[72:73], v[72:73], v[212:215]
    v_mfma_f32_4x4x4_16b_bf16 v[216:219], v[74:75], v[74:75], v[216:219]
    ds_read_b64_tr_b16 v[150:151], v230 offset:512
    v_mfma_f32_4x4x4_16b_bf16 v[212:215], v[76:77], v[76:77], v[212:215]
    v_mfma_f32_4x4x4_16b_bf16 v[216:219], v[78:79], v[78:79], v[216:219]
    s_waitcnt lgkmcnt(10)
    v_mfma_f32_32x32x16_bf16 v[160:175], v[80:83], v[128:131], v[160:175]
    ds_read_b128 v[92:95], v243 offset:49152
    v_add_u32 v227, 73728, v227
    ds_read_b64_tr_b16 v[152:153], v227 offset:0
    ds_read_b64_tr_b16 v[154:155], v227 offset:512
    v_mfma_f32_32x32x16_bf16 v[176:191], v[80:83], v[132:135], v[176:191]
    v_add_u32 v231, 73728, v231
    ds_read_b64_tr_b16 v[156:157], v231 offset:0
    ds_read_b64_tr_b16 v[158:159], v231 offset:512
    s_add_u32 s21, s21, 81920
    s_xor_b32 s22, s69, 2
    s_mul_i32 s22, s22, 3072
    v_mfma_f32_16x16x32_bf16 v[192:195], v[244:247], v[128:131], v[192:195]
    v_mfma_f32_16x16x32_bf16 v[196:199], v[244:247], v[132:135], v[196:199]
    s_waitcnt lgkmcnt(10)
    v_mfma_f32_32x32x16_bf16 v[160:175], v[84:87], v[136:139], v[160:175]
    s_add_u32 s22, s22, 81920
    s_xor_b32 s23, s69, 3
    s_mul_i32 s23, s23, 3072
    s_add_u32 s23, s23, 81920
    v_mfma_f32_32x32x16_bf16 v[176:191], v[84:87], v[140:143], v[176:191]
    s_waitcnt lgkmcnt(0)
    s_barrier
    v_mfma_f32_32x32x16_bf16 v[160:175], v[88:91], v[144:147], v[160:175]
    v_add_u32 v240, 4294893568, v240
    ds_read_b128 v[96:99], v240 offset:0
    v_add_u32 v224, 4294844416, v224
    ds_read_b64_tr_b16 v[128:129], v224 offset:0
    ds_read_b64_tr_b16 v[130:131], v224 offset:512
    v_mfma_f32_32x32x16_bf16 v[176:191], v[88:91], v[148:151], v[176:191]
    v_add_u32 v228, 4294844416, v228
    ds_read_b64_tr_b16 v[132:133], v228 offset:0
    ds_read_b64_tr_b16 v[134:135], v228 offset:512
    v_mfma_f32_32x32x16_bf16 v[160:175], v[92:95], v[152:155], v[160:175]
    v_add_u32 v241, 4294893568, v241
    ds_read_b128 v[100:103], v241 offset:0
    v_add_u32 v225, 4294844416, v225
    ds_read_b64_tr_b16 v[136:137], v225 offset:0
    ds_read_b64_tr_b16 v[138:139], v225 offset:512
    v_mfma_f32_32x32x16_bf16 v[176:191], v[92:95], v[156:159], v[176:191]
    v_add_u32 v229, 4294844416, v229
    ds_read_b64_tr_b16 v[140:141], v229 offset:0
    ds_read_b64_tr_b16 v[142:143], v229 offset:512
    v_mfma_f32_16x16x32_bf16 v[208:211], v[244:247], v[80:83], v[208:211]
    v_add_u32 v242, 4294893568, v242
    ds_read_b128 v[104:107], v242 offset:0
    v_mfma_f32_16x16x32_bf16 v[208:211], v[244:247], v[84:87], v[208:211]
    v_mfma_f32_16x16x32_bf16 v[208:211], v[244:247], v[88:91], v[208:211]
    v_add_u32 v226, 4294844416, v226
    ds_read_b64_tr_b16 v[144:145], v226 offset:0
    v_mfma_f32_16x16x32_bf16 v[208:211], v[244:247], v[92:95], v[208:211]
    v_mfma_f32_4x4x4_16b_bf16 v[212:215], v[80:81], v[80:81], v[212:215]
    v_mfma_f32_4x4x4_16b_bf16 v[216:219], v[82:83], v[82:83], v[216:219]
    ds_read_b64_tr_b16 v[146:147], v226 offset:512
    v_mfma_f32_4x4x4_16b_bf16 v[212:215], v[84:85], v[84:85], v[212:215]
    v_mfma_f32_4x4x4_16b_bf16 v[216:219], v[86:87], v[86:87], v[216:219]
    v_add_u32 v230, 4294844416, v230
    ds_read_b64_tr_b16 v[148:149], v230 offset:0
    v_mfma_f32_4x4x4_16b_bf16 v[212:215], v[88:89], v[88:89], v[212:215]
    v_mfma_f32_4x4x4_16b_bf16 v[216:219], v[90:91], v[90:91], v[216:219]
    ds_read_b64_tr_b16 v[150:151], v230 offset:512
    v_mfma_f32_4x4x4_16b_bf16 v[212:215], v[92:93], v[92:93], v[212:215]
    v_mfma_f32_4x4x4_16b_bf16 v[216:219], v[94:95], v[94:95], v[216:219]
    s_waitcnt lgkmcnt(10)
    v_mfma_f32_32x32x16_bf16 v[160:175], v[96:99], v[128:131], v[160:175]
    v_add_u32 v243, 4294893568, v243
    ds_read_b128 v[108:111], v243 offset:0
    v_add_u32 v227, 4294844416, v227
    ds_read_b64_tr_b16 v[152:153], v227 offset:0
    ds_read_b64_tr_b16 v[154:155], v227 offset:512
    v_mfma_f32_32x32x16_bf16 v[176:191], v[96:99], v[132:135], v[176:191]
    v_add_u32 v231, 4294844416, v231
    ds_read_b64_tr_b16 v[156:157], v231 offset:0
    ds_read_b64_tr_b16 v[158:159], v231 offset:512
    v_mfma_f32_16x16x32_bf16 v[192:195], v[244:247], v[128:131], v[192:195]
    v_mfma_f32_16x16x32_bf16 v[196:199], v[244:247], v[132:135], v[196:199]
    s_waitcnt lgkmcnt(10)
    v_mfma_f32_32x32x16_bf16 v[160:175], v[100:103], v[136:139], v[160:175]
    v_mfma_f32_32x32x16_bf16 v[176:191], v[100:103], v[140:143], v[176:191]
    s_waitcnt lgkmcnt(0)
    s_barrier
    v_mfma_f32_32x32x16_bf16 v[160:175], v[104:107], v[144:147], v[160:175]
    ds_read_b128 v[112:115], v240 offset:24576
    ds_read_b64_tr_b16 v[128:129], v224 offset:24576
    ds_read_b64_tr_b16 v[130:131], v224 offset:25088
    v_mfma_f32_32x32x16_bf16 v[176:191], v[104:107], v[148:151], v[176:191]
    ds_read_b64_tr_b16 v[132:133], v228 offset:24576
    ds_read_b64_tr_b16 v[134:135], v228 offset:25088
    v_mfma_f32_32x32x16_bf16 v[160:175], v[108:111], v[152:155], v[160:175]
    ds_read_b128 v[116:119], v241 offset:24576
    ds_read_b64_tr_b16 v[136:137], v225 offset:24576
    ds_read_b64_tr_b16 v[138:139], v225 offset:25088
    v_mfma_f32_32x32x16_bf16 v[176:191], v[108:111], v[156:159], v[176:191]
    ds_read_b64_tr_b16 v[140:141], v229 offset:24576
    ds_read_b64_tr_b16 v[142:143], v229 offset:25088
    v_mfma_f32_16x16x32_bf16 v[208:211], v[244:247], v[96:99], v[208:211]
    ds_read_b128 v[120:123], v242 offset:24576
    v_mfma_f32_16x16x32_bf16 v[208:211], v[244:247], v[100:103], v[208:211]
    v_mfma_f32_16x16x32_bf16 v[208:211], v[244:247], v[104:107], v[208:211]
    ds_read_b64_tr_b16 v[144:145], v226 offset:24576
    v_mfma_f32_16x16x32_bf16 v[208:211], v[244:247], v[108:111], v[208:211]
    v_mfma_f32_4x4x4_16b_bf16 v[212:215], v[96:97], v[96:97], v[212:215]
    v_mfma_f32_4x4x4_16b_bf16 v[216:219], v[98:99], v[98:99], v[216:219]
    ds_read_b64_tr_b16 v[146:147], v226 offset:25088
    v_mfma_f32_4x4x4_16b_bf16 v[212:215], v[100:101], v[100:101], v[212:215]
    v_mfma_f32_4x4x4_16b_bf16 v[216:219], v[102:103], v[102:103], v[216:219]
    ds_read_b64_tr_b16 v[148:149], v230 offset:24576
    v_mfma_f32_4x4x4_16b_bf16 v[212:215], v[104:105], v[104:105], v[212:215]
    v_mfma_f32_4x4x4_16b_bf16 v[216:219], v[106:107], v[106:107], v[216:219]
    ds_read_b64_tr_b16 v[150:151], v230 offset:25088
    v_mfma_f32_4x4x4_16b_bf16 v[212:215], v[108:109], v[108:109], v[212:215]
    v_mfma_f32_4x4x4_16b_bf16 v[216:219], v[110:111], v[110:111], v[216:219]
    s_waitcnt lgkmcnt(10)
    v_mfma_f32_32x32x16_bf16 v[160:175], v[112:115], v[128:131], v[160:175]
    ds_read_b128 v[124:127], v243 offset:24576
    ds_read_b64_tr_b16 v[152:153], v227 offset:24576
    ds_read_b64_tr_b16 v[154:155], v227 offset:25088
    v_mfma_f32_32x32x16_bf16 v[176:191], v[112:115], v[132:135], v[176:191]
    ds_read_b64_tr_b16 v[156:157], v231 offset:24576
    ds_read_b64_tr_b16 v[158:159], v231 offset:25088
    v_mfma_f32_16x16x32_bf16 v[192:195], v[244:247], v[128:131], v[192:195]
    v_mfma_f32_16x16x32_bf16 v[196:199], v[244:247], v[132:135], v[196:199]
    s_waitcnt lgkmcnt(10)
    v_mfma_f32_16x16x32_bf16 v[208:211], v[244:247], v[112:115], v[208:211]
    v_mfma_f32_16x16x32_bf16 v[208:211], v[244:247], v[116:119], v[208:211]
    s_waitcnt lgkmcnt(0)
    v_mfma_f32_16x16x32_bf16 v[208:211], v[244:247], v[120:123], v[208:211]
    v_mfma_f32_16x16x32_bf16 v[208:211], v[244:247], v[124:127], v[208:211]
    v_mfma_f32_4x4x4_16b_bf16 v[212:215], v[112:113], v[112:113], v[212:215]
    v_mfma_f32_4x4x4_16b_bf16 v[216:219], v[114:115], v[114:115], v[216:219]
    s_nop 0
    v_mfma_f32_4x4x4_16b_bf16 v[212:215], v[116:117], v[116:117], v[212:215]
    v_mfma_f32_4x4x4_16b_bf16 v[216:219], v[118:119], v[118:119], v[216:219]
    ds_write_b32 v202, v192 offset:0
    v_mfma_f32_4x4x4_16b_bf16 v[212:215], v[120:121], v[120:121], v[212:215]
    v_mfma_f32_4x4x4_16b_bf16 v[216:219], v[122:123], v[122:123], v[216:219]
    ds_write_b32 v202, v196 offset:512
    v_mfma_f32_4x4x4_16b_bf16 v[212:215], v[124:125], v[124:125], v[212:215]
    v_mfma_f32_4x4x4_16b_bf16 v[216:219], v[126:127], v[126:127], v[216:219]
    v_mfma_f32_32x32x16_bf16 v[160:175], v[116:119], v[136:139], v[160:175]
    v_mov_b32 v240, v203
    v_xor_b32 v241, 1024, v203
    v_xor_b32 v242, 2048, v203
    v_xor_b32 v243, 3072, v203
    s_waitcnt lgkmcnt(0)
    s_barrier
    v_mfma_f32_32x32x16_bf16 v[176:191], v[116:119], v[140:143], v[176:191]
    ds_read_b128 v[192:195], v201
    ds_read_b128 v[196:199], v201 offset:512
    ds_read_b64_tr_b16 v[128:129], v240 offset:0
    ds_read_b64_tr_b16 v[130:131], v240 offset:256
    v_add_f32 v212, v212, v216
    v_add_f32 v213, v213, v217
    v_mfma_f32_32x32x16_bf16 v[160:175], v[120:123], v[144:147], v[160:175]
    ds_read_b64_tr_b16 v[132:133], v241 offset:0
    ds_read_b64_tr_b16 v[134:135], v241 offset:256
    v_add_f32 v214, v214, v218
    v_add_f32 v215, v215, v219
    v_cndmask_b32 v249, v212, v213, vcc
    v_cndmask_b32 v249, v249, v214, s[76:77]
    v_mfma_f32_32x32x16_bf16 v[176:191], v[120:123], v[148:151], v[176:191]
    ds_read_b64_tr_b16 v[136:137], v242 offset:0
    ds_read_b64_tr_b16 v[138:139], v242 offset:256
    v_cndmask_b32 v249, v249, v215, s[78:79]
    v_mov_b32 v250, v249
    v_mul_f32 v200, 0x3b000000, v208
    v_cvt_pk_bf16_f32 v224, -v200, -v200
    v_mfma_f32_32x32x16_bf16 v[160:175], v[124:127], v[152:155], v[160:175]
    ds_read_b64_tr_b16 v[140:141], v243 offset:0
    ds_read_b64_tr_b16 v[142:143], v243 offset:256
    v_permlane32_swap_b32 v249, v250
    v_add_f32 v249, v249, v250
    v_mul_f32 v249, 0x3b000000, v249
    v_fma_f32 v249, -v200, v200, v249
    v_mfma_f32_32x32x16_bf16 v[176:191], v[124:127], v[156:159], v[176:191]
    ds_read_b64_tr_b16 v[144:145], v240 offset:4096
    ds_read_b64_tr_b16 v[146:147], v240 offset:4352
    v_max_f32 v249, 0, v249
    v_cvt_pk_bf16_f32 v249, v249, v249
    v_lshlrev_b32 v249, 16, v249
    v_add_f32 v249, 0x3727c5ac, v249
    ds_read_b64_tr_b16 v[148:149], v241 offset:4096
    ds_read_b64_tr_b16 v[150:151], v241 offset:4352
    s_branch L_C2
.p2align 12
L_C2:
L_pad0:
    s_cbranch_execz L_pad4
    s_waitcnt lgkmcnt(10)
    v_mfma_f32_32x32x16_bf16 v[208:223], v[128:131], v[0:3], 0
    ds_read_b64_tr_b16 v[152:153], v242 offset:4096
    ds_read_b64_tr_b16 v[154:155], v242 offset:4352
    v_cvt_pk_bf16_f32 v249, v249, v249
    v_lshlrev_b32 v249, 16, v249
    v_sqrt_f32 v249, v249
    s_waitcnt vmcnt(0)
    v_mfma_f32_16x16x32_bf16 v[236:239], v[244:247], v[128:131], 0
    s_waitcnt lgkmcnt(10)
    v_mfma_f32_32x32x16_bf16 v[208:223], v[132:135], v[4:7], v[208:223]
    ds_read_b64_tr_b16 v[156:157], v243 offset:4096
    ds_read_b64_tr_b16 v[158:159], v243 offset:4352
    v_cvt_pk_bf16_f32 v225, -v200, v249
    v_and_b32 v249, 0xffff0000, v225
    v_rcp_f32 v248, v249
    v_and_b32 v224, v224, v206
    s_waitcnt lgkmcnt(10)
    v_mfma_f32_32x32x16_bf16 v[208:223], v[136:139], v[8:11], v[208:223]
    ds_read_b64_tr_b16 v[128:129], v240 offset:8192
    ds_read_b64_tr_b16 v[130:131], v240 offset:8448
    v_and_b32 v225, v225, v206
    ds_write_b32 v204, v248
    v_mov_b64 v[226:227], 0
    v_mov_b64 v[230:231], 0
    s_waitcnt lgkmcnt(11)
    v_mfma_f32_32x32x16_bf16 v[208:223], v[140:143], v[12:15], v[208:223]
    ds_read_b64_tr_b16 v[132:133], v241 offset:8192
    ds_read_b64_tr_b16 v[134:135], v241 offset:8448
    v_add_f32 v192, v192, v193
    v_add_f32 v194, v194, v195
    v_add_f32 v192, v192, v194
    s_waitcnt lgkmcnt(11)
    v_mfma_f32_32x32x16_bf16 v[208:223], v[144:147], v[16:19], v[208:223]
    ds_read_b64_tr_b16 v[136:137], v242 offset:8192
    ds_read_b64_tr_b16 v[138:139], v242 offset:8448
    v_cvt_pk_bf16_f32 v249, v192, v192
    v_lshlrev_b32 v249, 16, v249
    v_sub_f32 v249, v192, v249
    v_cvt_pk_bf16_f32 v228, v192, v249
    v_mfma_f32_16x16x32_bf16 v[236:239], v[244:247], v[144:147], v[236:239]
    s_waitcnt lgkmcnt(11)
    v_mfma_f32_32x32x16_bf16 v[208:223], v[148:151], v[20:23], v[208:223]
    ds_read_b64_tr_b16 v[140:141], v243 offset:8192
    ds_read_b64_tr_b16 v[142:143], v243 offset:8448
    v_and_b32 v250, 0xffff0000, v228
    v_sub_f32 v250, v249, v250
    v_cvt_pk_bf16_f32 v229, v250, 0
    v_add_f32 v196, v196, v197
    s_waitcnt lgkmcnt(11)
    v_mfma_f32_32x32x16_bf16 v[208:223], v[152:155], v[24:27], v[208:223]
    ds_read_b64_tr_b16 v[144:145], v240 offset:12288
    ds_read_b64_tr_b16 v[146:147], v240 offset:12544
    v_add_f32 v198, v198, v199
    v_add_f32 v196, v196, v198
    v_cvt_pk_bf16_f32 v249, v196, v196
    v_lshlrev_b32 v249, 16, v249
    s_waitcnt lgkmcnt(11)
    v_mfma_f32_32x32x16_bf16 v[208:223], v[156:159], v[28:31], v[208:223]
    ds_read_b64_tr_b16 v[148:149], v241 offset:12288
    ds_read_b64_tr_b16 v[150:151], v241 offset:12544
    v_sub_f32 v249, v196, v249
    v_cvt_pk_bf16_f32 v232, v196, v249
    v_and_b32 v250, 0xffff0000, v232
    v_sub_f32 v250, v249, v250
    s_waitcnt lgkmcnt(11)
    v_mfma_f32_32x32x16_bf16 v[208:223], v[128:131], v[32:35], v[208:223]
    ds_read_b64_tr_b16 v[152:153], v242 offset:12288
    ds_read_b64_tr_b16 v[154:155], v242 offset:12544
    v_cvt_pk_bf16_f32 v233, v250, 0
    ds_read_b128 v[192:195], v205 offset:0
    ds_read_b128 v[196:199], v205 offset:32
    s_waitcnt lgkmcnt(14)
    ds_read_b128 v[200:203], v205 offset:64
    v_mfma_f32_16x16x32_bf16 v[236:239], v[244:247], v[128:131], v[236:239]
    s_waitcnt lgkmcnt(13)
    v_mfma_f32_32x32x16_bf16 v[208:223], v[132:135], v[36:39], v[208:223]
    ds_read_b64_tr_b16 v[156:157], v243 offset:12288
    ds_read_b64_tr_b16 v[158:159], v243 offset:12544
    s_waitcnt lgkmcnt(14)
    ds_read_b128 v[204:207], v205 offset:96
    s_bitcmp1_b32 s71, 0
    s_cbranch_scc1 L_auxv
    v_mfma_f32_32x32x16_bf16 v[160:175], v[228:231], v[224:227], v[160:175]
    v_mfma_f32_32x32x16_bf16 v[176:191], v[232:235], v[224:227], v[176:191]
    s_waitcnt lgkmcnt(0)
    v_mov_b32 v192, v248
    v_mov_b32 v193, v248
    v_mov_b64 v[194:195], v[192:193]
    v_mov_b64 v[196:197], v[192:193]
    v_mov_b64 v[198:199], v[192:193]
    v_mov_b64 v[200:201], v[192:193]
    v_mov_b64 v[202:203], v[192:193]
    v_mov_b64 v[204:205], v[192:193]
    v_mov_b64 v[206:207], v[192:193]
    s_branch L_auxd
L_auxv:
    v_mfma_f32_32x32x16_bf16 v[160:175], v[224:227], v[228:231], v[160:175]
    v_mfma_f32_32x32x16_bf16 v[176:191], v[224:227], v[232:235], v[176:191]
L_auxd:
    v_bfe_u32 v249, v252, 2, 2
    v_mad_u32_u24 v249, v253, 8, v249
    s_waitcnt lgkmcnt(14)
    v_mfma_f32_32x32x16_bf16 v[208:223], v[136:139], v[40:43], v[208:223]
    s_barrier
    s_waitcnt lgkmcnt(13)
    ds_read_b64_tr_b16 v[128:129], v240 offset:16384
    ds_read_b64_tr_b16 v[130:131], v240 offset:16640
    v_mul_u32_u24 v249, 192, v249
    v_add_u32 v250, v249, v255
    s_waitcnt lgkmcnt(2)
    v_mul_f32 v160, v160, v192
    v_mfma_f32_32x32x16_bf16 v[208:223], v[140:143], v[44:47], v[208:223]
    ds_read_b64_tr_b16 v[132:133], v241 offset:16384
    ds_read_b64_tr_b16 v[134:135], v241 offset:16640
    v_mul_f32 v161, v161, v193
    v_mul_f32 v162, v162, v194
    v_mul_f32 v163, v163, v195
    v_mul_f32 v164, v164, v196
    v_mfma_f32_32x32x16_bf16 v[208:223], v[144:147], v[48:51], v[208:223]
    ds_read_b64_tr_b16 v[136:137], v242 offset:16384
    ds_read_b64_tr_b16 v[138:139], v242 offset:16640
    v_mul_f32 v165, v165, v197
    v_mul_f32 v166, v166, v198
    v_mul_f32 v167, v167, v199
    v_cvt_pk_bf16_f32 v160, v160, v161
    v_mfma_f32_16x16x32_bf16 v[236:239], v[244:247], v[144:147], v[236:239]
    v_mfma_f32_32x32x16_bf16 v[208:223], v[148:151], v[52:55], v[208:223]
    ds_read_b64_tr_b16 v[140:141], v243 offset:16384
    ds_read_b64_tr_b16 v[142:143], v243 offset:16640
    v_cvt_pk_bf16_f32 v161, v162, v163
    v_cvt_pk_bf16_f32 v162, v164, v165
    v_cvt_pk_bf16_f32 v163, v166, v167
    buffer_store_dwordx4 v[160:163], v251, s[52:55], s75 offen sc1
    v_mfma_f32_32x32x16_bf16 v[208:223], v[152:155], v[56:59], v[208:223]
    ds_read_b64_tr_b16 v[144:145], v240 offset:20480
    ds_read_b64_tr_b16 v[146:147], v240 offset:20736
    s_add_u32 s75, s75, s8
    v_mul_f32 v168, v168, v200
    v_mul_f32 v169, v169, v201
    v_mul_f32 v170, v170, v202
    v_mfma_f32_32x32x16_bf16 v[208:223], v[156:159], v[60:63], v[208:223]
    ds_read_b64_tr_b16 v[148:149], v241 offset:20480
    ds_read_b64_tr_b16 v[150:151], v241 offset:20736
    v_mul_f32 v171, v171, v203
    v_mul_f32 v172, v172, v204
    v_mul_f32 v173, v173, v205
    v_mul_f32 v174, v174, v206
    s_waitcnt lgkmcnt(10)
    v_mfma_f32_32x32x16_bf16 v[208:223], v[128:131], v[64:67], v[208:223]
    ds_read_b64_tr_b16 v[152:153], v242 offset:20480
    ds_read_b64_tr_b16 v[154:155], v242 offset:20736
    v_mul_f32 v175, v175, v207
    v_cvt_pk_bf16_f32 v168, v168, v169
    v_cvt_pk_bf16_f32 v169, v170, v171
    v_cvt_pk_bf16_f32 v170, v172, v173
    v_mfma_f32_16x16x32_bf16 v[236:239], v[244:247], v[128:131], v[236:239]
    s_waitcnt lgkmcnt(10)
    v_mfma_f32_32x32x16_bf16 v[208:223], v[132:135], v[68:71], v[208:223]
    ds_read_b64_tr_b16 v[156:157], v243 offset:20480
    ds_read_b64_tr_b16 v[158:159], v243 offset:20736
    v_cvt_pk_bf16_f32 v171, v174, v175
    buffer_store_dwordx4 v[168:171], v251, s[52:55], s75 offen sc1
    s_add_u32 s75, s75, s9
    v_mul_f32 v176, v176, v192
    s_waitcnt lgkmcnt(10)
    v_mfma_f32_32x32x16_bf16 v[208:223], v[136:139], v[72:75], v[208:223]
    ds_read_b64_tr_b16 v[128:129], v240 offset:24576
    ds_read_b64_tr_b16 v[130:131], v240 offset:24832
    v_mul_f32 v177, v177, v193
    v_mul_f32 v178, v178, v194
    v_mul_f32 v179, v179, v195
    v_mul_f32 v180, v180, v196
    s_waitcnt lgkmcnt(10)
    v_mfma_f32_32x32x16_bf16 v[208:223], v[140:143], v[76:79], v[208:223]
    ds_read_b64_tr_b16 v[132:133], v241 offset:24576
    ds_read_b64_tr_b16 v[134:135], v241 offset:24832
    v_mul_f32 v181, v181, v197
    v_mul_f32 v182, v182, v198
    v_mul_f32 v183, v183, v199
    v_cvt_pk_bf16_f32 v176, v176, v177
    s_waitcnt lgkmcnt(10)
    v_mfma_f32_32x32x16_bf16 v[208:223], v[144:147], v[80:83], v[208:223]
    ds_read_b64_tr_b16 v[136:137], v242 offset:24576
    ds_read_b64_tr_b16 v[138:139], v242 offset:24832
    v_cvt_pk_bf16_f32 v177, v178, v179
    v_cvt_pk_bf16_f32 v178, v180, v181
    v_cvt_pk_bf16_f32 v179, v182, v183
    buffer_store_dwordx4 v[176:179], v251, s[52:55], s75 offen sc1
    v_mfma_f32_16x16x32_bf16 v[236:239], v[244:247], v[144:147], v[236:239]
    s_waitcnt lgkmcnt(10)
    v_mfma_f32_32x32x16_bf16 v[208:223], v[148:151], v[84:87], v[208:223]
    ds_read_b64_tr_b16 v[140:141], v243 offset:24576
    ds_read_b64_tr_b16 v[142:143], v243 offset:24832
    s_add_u32 s75, s75, s8
    v_mul_f32 v184, v184, v200
    v_mul_f32 v185, v185, v201
    v_mul_f32 v186, v186, v202
    s_waitcnt lgkmcnt(10)
    v_mfma_f32_32x32x16_bf16 v[208:223], v[152:155], v[88:91], v[208:223]
    ds_read_b64_tr_b16 v[144:145], v240 offset:28672
    ds_read_b64_tr_b16 v[146:147], v240 offset:28928
    v_add_u32 v240, s20, v250
    v_mul_f32 v187, v187, v203
    v_mul_f32 v188, v188, v204
    v_mul_f32 v189, v189, v205
    v_mul_f32 v190, v190, v206
    s_waitcnt lgkmcnt(10)
    v_mfma_f32_32x32x16_bf16 v[208:223], v[156:159], v[92:95], v[208:223]
    ds_read_b64_tr_b16 v[148:149], v241 offset:28672
    ds_read_b64_tr_b16 v[150:151], v241 offset:28928
    v_add_u32 v241, s21, v250
    v_mul_f32 v191, v191, v207
    v_cvt_pk_bf16_f32 v184, v184, v185
    v_cvt_pk_bf16_f32 v185, v186, v187
    v_cvt_pk_bf16_f32 v186, v188, v189
    s_waitcnt lgkmcnt(10)
    v_mfma_f32_32x32x16_bf16 v[208:223], v[128:131], v[96:99], v[208:223]
    ds_read_b64_tr_b16 v[152:153], v242 offset:28672
    ds_read_b64_tr_b16 v[154:155], v242 offset:28928
    v_add_u32 v242, s22, v250
    v_cvt_pk_bf16_f32 v187, v190, v191
    buffer_store_dwordx4 v[184:187], v251, s[52:55], s75 offen sc1
    v_mfma_f32_16x16x32_bf16 v[236:239], v[244:247], v[128:131], v[236:239]
    s_waitcnt lgkmcnt(10)
    v_mfma_f32_32x32x16_bf16 v[208:223], v[132:135], v[100:103], v[208:223]
    ds_read_b64_tr_b16 v[156:157], v243 offset:28672
    ds_read_b64_tr_b16 v[158:159], v243 offset:28928
    v_add_u32 v243, s23, v250
    s_waitcnt lgkmcnt(10)
    v_mfma_f32_32x32x16_bf16 v[208:223], v[136:139], v[104:107], v[208:223]
    s_barrier
    ds_read_b64_tr_b16 v[128:129], v240 offset:0
    ds_read_b64_tr_b16 v[130:131], v240 offset:768
    s_waitcnt lgkmcnt(10)
    v_mfma_f32_32x32x16_bf16 v[208:223], v[140:143], v[108:111], v[208:223]
    ds_read_b64_tr_b16 v[132:133], v240 offset:64
    ds_read_b64_tr_b16 v[134:135], v240 offset:832
    v_lshlrev_b32 v251, 4, v254
    v_add_u32 v251, 158720, v251
    s_waitcnt lgkmcnt(10)
    v_mfma_f32_32x32x16_bf16 v[208:223], v[144:147], v[112:115], v[208:223]
    ds_read_b64_tr_b16 v[136:137], v240 offset:128
    ds_read_b64_tr_b16 v[138:139], v240 offset:896
    s_lshl_b32 s73, s69, 2
    v_add_u32 v249, s73, v251
    v_mfma_f32_16x16x32_bf16 v[236:239], v[244:247], v[144:147], v[236:239]
    s_waitcnt lgkmcnt(10)
    v_mfma_f32_32x32x16_bf16 v[208:223], v[148:151], v[116:119], v[208:223]
    ds_read_b64_tr_b16 v[140:141], v241 offset:0
    ds_read_b64_tr_b16 v[142:143], v241 offset:768
    s_waitcnt lgkmcnt(10)
    v_mfma_f32_32x32x16_bf16 v[208:223], v[152:155], v[120:123], v[208:223]
    ds_read_b64_tr_b16 v[144:145], v241 offset:64
    ds_read_b64_tr_b16 v[146:147], v241 offset:832
    ds_write_b32 v249, v236
    s_waitcnt lgkmcnt(11)
    v_mfma_f32_32x32x16_bf16 v[208:223], v[156:159], v[124:127], v[208:223]
    ds_read_b64_tr_b16 v[148:149], v241 offset:128
    ds_read_b64_tr_b16 v[150:151], v241 offset:896
    s_waitcnt lgkmcnt(11)
    v_mfma_f32_32x32x16_bf16 v[160:175], v[128:131], v[0:3], 0
    ds_read_b64_tr_b16 v[152:153], v242 offset:0
    ds_read_b64_tr_b16 v[154:155], v242 offset:768
    s_waitcnt lgkmcnt(11)
    v_mfma_f32_32x32x16_bf16 v[176:191], v[132:135], v[0:3], 0
    s_waitcnt lgkmcnt(4)
    s_barrier
    ds_read_b64_tr_b16 v[156:157], v242 offset:64
    ds_read_b64_tr_b16 v[158:159], v242 offset:832
    ds_read_b128 v[232:235], v251
    s_lshl_b32 s73, s69, 10
    v_mfma_f32_32x32x16_bf16 v[192:207], v[136:139], v[0:3], 0
    ds_read_b64_tr_b16 v[128:129], v242 offset:128
    ds_read_b64_tr_b16 v[130:131], v242 offset:896
    s_add_u32 s73, s73, 147456
    v_mfma_f32_32x32x16_bf16 v[160:175], v[140:143], v[4:7], v[160:175]
    ds_read_b64_tr_b16 v[132:133], v243 offset:0
    ds_read_b64_tr_b16 v[134:135], v243 offset:768
    v_mfma_f32_32x32x16_bf16 v[176:191], v[144:147], v[4:7], v[176:191]
    ds_read_b64_tr_b16 v[136:137], v243 offset:64
    ds_read_b64_tr_b16 v[138:139], v243 offset:832
    s_waitcnt lgkmcnt(6)
    v_add_f32 v232, v232, v233
    v_mfma_f32_32x32x16_bf16 v[192:207], v[148:151], v[4:7], v[192:207]
    ds_read_b64_tr_b16 v[140:141], v243 offset:128
    ds_read_b64_tr_b16 v[142:143], v243 offset:896
    v_add_f32 v234, v234, v235
    v_add_f32 v232, v232, v234
    v_mfma_f32_32x32x16_bf16 v[160:175], v[152:155], v[8:11], v[160:175]
    ds_read_b64_tr_b16 v[144:145], v240 offset:12288
    ds_read_b64_tr_b16 v[146:147], v240 offset:13056
    v_cvt_pk_bf16_f32 v249, v232, v232
    v_lshlrev_b32 v249, 16, v249
    v_mfma_f32_32x32x16_bf16 v[176:191], v[156:159], v[8:11], v[176:191]
    ds_read_b64_tr_b16 v[148:149], v240 offset:12352
    ds_read_b64_tr_b16 v[150:151], v240 offset:13120
    v_sub_f32 v249, v232, v249
    v_cvt_pk_bf16_f32 v228, v232, v249
    s_waitcnt lgkmcnt(10)
    v_mfma_f32_32x32x16_bf16 v[192:207], v[128:131], v[8:11], v[192:207]
    ds_read_b64_tr_b16 v[152:153], v240 offset:12416
    ds_read_b64_tr_b16 v[154:155], v240 offset:13184
    v_and_b32 v250, 0xffff0000, v228
    v_sub_f32 v250, v249, v250
    s_waitcnt lgkmcnt(10)
    v_mfma_f32_32x32x16_bf16 v[160:175], v[132:135], v[12:15], v[160:175]
    ds_read_b64_tr_b16 v[156:157], v241 offset:12288
    ds_read_b64_tr_b16 v[158:159], v241 offset:13056
    v_cvt_pk_bf16_f32 v229, v250, 0
    v_lshl_add_u32 v250, v252, 4, s73
    v_mfma_f32_16x16x32_bf16 v[0:3], v[244:247], v[132:135], 0
    s_waitcnt lgkmcnt(10)
    v_mfma_f32_32x32x16_bf16 v[176:191], v[136:139], v[12:15], v[176:191]
    ds_read_b64_tr_b16 v[128:129], v241 offset:12352
    ds_read_b64_tr_b16 v[130:131], v241 offset:13120
    v_mfma_f32_32x32x16_bf16 v[208:223], v[228:231], v[224:227], v[208:223]
    v_mul_f32 v249, 0x3eb8aa3b, v248
    v_mfma_f32_16x16x32_bf16 v[4:7], v[244:247], v[136:139], 0
    s_waitcnt lgkmcnt(10)
    v_mfma_f32_32x32x16_bf16 v[192:207], v[140:143], v[12:15], v[192:207]
    ds_read_b64_tr_b16 v[132:133], v241 offset:12416
    ds_read_b64_tr_b16 v[134:135], v241 offset:13184
    v_mfma_f32_16x16x32_bf16 v[8:11], v[244:247], v[140:143], 0
    s_waitcnt lgkmcnt(10)
    v_mfma_f32_32x32x16_bf16 v[160:175], v[144:147], v[16:19], v[160:175]
    ds_read_b64_tr_b16 v[136:137], v242 offset:12288
    ds_read_b64_tr_b16 v[138:139], v242 offset:13056
    v_mfma_f32_16x16x32_bf16 v[0:3], v[244:247], v[144:147], v[0:3]
    s_waitcnt lgkmcnt(10)
    v_mfma_f32_32x32x16_bf16 v[176:191], v[148:151], v[16:19], v[176:191]
    ds_read_b64_tr_b16 v[140:141], v242 offset:12352
    ds_read_b64_tr_b16 v[142:143], v242 offset:13120
    v_mul_f32 v208, v208, v249
    v_mul_f32 v209, v209, v249
    v_mfma_f32_16x16x32_bf16 v[4:7], v[244:247], v[148:151], v[4:7]
    s_waitcnt lgkmcnt(10)
    v_mfma_f32_32x32x16_bf16 v[192:207], v[152:155], v[16:19], v[192:207]
    ds_read_b64_tr_b16 v[144:145], v242 offset:12416
    ds_read_b64_tr_b16 v[146:147], v242 offset:13184
    v_mul_f32 v210, v210, v249
    v_mul_f32 v211, v211, v249
    v_mfma_f32_16x16x32_bf16 v[8:11], v[244:247], v[152:155], v[8:11]
    s_waitcnt lgkmcnt(10)
    v_mfma_f32_32x32x16_bf16 v[160:175], v[156:159], v[20:23], v[160:175]
    ds_read_b64_tr_b16 v[148:149], v243 offset:12288
    ds_read_b64_tr_b16 v[150:151], v243 offset:13056
    v_mul_f32 v212, v212, v249
    v_mul_f32 v213, v213, v249
    s_waitcnt lgkmcnt(10)
    v_mfma_f32_32x32x16_bf16 v[176:191], v[128:131], v[20:23], v[176:191]
    ds_read_b64_tr_b16 v[152:153], v243 offset:12352
    ds_read_b64_tr_b16 v[154:155], v243 offset:13120
    v_mul_f32 v214, v214, v249
    v_mul_f32 v215, v215, v249
    s_waitcnt lgkmcnt(10)
    v_mfma_f32_32x32x16_bf16 v[192:207], v[132:135], v[20:23], v[192:207]
    ds_read_b64_tr_b16 v[156:157], v243 offset:12416
    ds_read_b64_tr_b16 v[158:159], v243 offset:13184
    v_mul_f32 v216, v216, v249
    v_mul_f32 v217, v217, v249
    s_and_b32 s76, s16, 0xfffff3ff
    v_mov_b32 v236, 1
    v_lshlrev_b32 v237, 10, v252
    s_waitcnt vmcnt(0)
    s_mov_b64 exec, 15
    buffer_atomic_add v236, v237, s[52:55], s76 offen offset:48 sc1
    s_mov_b64 exec, -1
    s_waitcnt lgkmcnt(10)
    v_mfma_f32_32x32x16_bf16 v[160:175], v[136:139], v[24:27], v[160:175]
    s_barrier
    ds_read_b64_tr_b16 v[128:129], v240 offset:24576
    ds_read_b64_tr_b16 v[130:131], v240 offset:25344
    v_mul_f32 v218, v218, v249
    v_mul_f32 v219, v219, v249
    s_waitcnt lgkmcnt(10)
    v_mfma_f32_32x32x16_bf16 v[176:191], v[140:143], v[24:27], v[176:191]
    ds_read_b64_tr_b16 v[132:133], v240 offset:24640
    ds_read_b64_tr_b16 v[134:135], v240 offset:25408
    v_mul_f32 v220, v220, v249
    v_mul_f32 v221, v221, v249
    s_waitcnt lgkmcnt(10)
    v_mfma_f32_32x32x16_bf16 v[192:207], v[144:147], v[24:27], v[192:207]
    ds_read_b64_tr_b16 v[136:137], v240 offset:24704
    ds_read_b64_tr_b16 v[138:139], v240 offset:25472
    v_mul_f32 v222, v222, v249
    v_mul_f32 v223, v223, v249
    s_waitcnt lgkmcnt(10)
    v_mfma_f32_32x32x16_bf16 v[160:175], v[148:151], v[28:31], v[160:175]
    ds_read_b64_tr_b16 v[140:141], v241 offset:24576
    ds_read_b64_tr_b16 v[142:143], v241 offset:25344
    v_cvt_pk_bf16_f32 v208, v208, v209
    v_cvt_pk_bf16_f32 v209, v210, v211
    s_waitcnt lgkmcnt(10)
    v_mfma_f32_32x32x16_bf16 v[176:191], v[152:155], v[28:31], v[176:191]
    ds_read_b64_tr_b16 v[144:145], v241 offset:24640
    ds_read_b64_tr_b16 v[146:147], v241 offset:25408
    v_cvt_pk_bf16_f32 v210, v212, v213
    v_cvt_pk_bf16_f32 v211, v214, v215
    s_waitcnt lgkmcnt(10)
    v_mfma_f32_32x32x16_bf16 v[192:207], v[156:159], v[28:31], v[192:207]
    ds_read_b64_tr_b16 v[148:149], v241 offset:24704
    ds_read_b64_tr_b16 v[150:151], v241 offset:25472
    ds_write_b128 v250, v[208:211] offset:0
    v_cvt_pk_bf16_f32 v212, v216, v217
    s_waitcnt lgkmcnt(11)
    v_mfma_f32_32x32x16_bf16 v[160:175], v[128:131], v[32:35], v[160:175]
    ds_read_b64_tr_b16 v[152:153], v242 offset:24576
    ds_read_b64_tr_b16 v[154:155], v242 offset:25344
    v_cvt_pk_bf16_f32 v213, v218, v219
    v_cvt_pk_bf16_f32 v214, v220, v221
    v_mfma_f32_16x16x32_bf16 v[0:3], v[244:247], v[128:131], v[0:3]
    s_waitcnt lgkmcnt(11)
    v_mfma_f32_32x32x16_bf16 v[176:191], v[132:135], v[32:35], v[176:191]
    ds_read_b64_tr_b16 v[156:157], v242 offset:24640
    ds_read_b64_tr_b16 v[158:159], v242 offset:25408
    v_cvt_pk_bf16_f32 v215, v222, v223
    ds_write_b128 v250, v[212:215] offset:4096
    v_mfma_f32_16x16x32_bf16 v[4:7], v[244:247], v[132:135], v[4:7]
    s_waitcnt lgkmcnt(12)
    v_mfma_f32_32x32x16_bf16 v[192:207], v[136:139], v[32:35], v[192:207]
    ds_read_b64_tr_b16 v[128:129], v242 offset:24704
    ds_read_b64_tr_b16 v[130:131], v242 offset:25472
    v_lshlrev_b32 v237, 4, v252
    v_and_b32 v238, 15, v252
    v_mfma_f32_16x16x32_bf16 v[8:11], v[244:247], v[136:139], v[8:11]
    s_waitcnt lgkmcnt(12)
    v_mfma_f32_32x32x16_bf16 v[160:175], v[140:143], v[36:39], v[160:175]
    ds_read_b64_tr_b16 v[132:133], v243 offset:24576
    ds_read_b64_tr_b16 v[134:135], v243 offset:25344
    v_lshlrev_b32 v238, 4, v238
    v_lshl_add_u32 v238, v253, 8, v238
    s_waitcnt lgkmcnt(12)
    v_mfma_f32_32x32x16_bf16 v[176:191], v[144:147], v[36:39], v[176:191]
    ds_read_b64_tr_b16 v[136:137], v243 offset:24640
    ds_read_b64_tr_b16 v[138:139], v243 offset:25408
    v_mov_b32 v236, 0xdddddddd
    v_bfe_u32 v249, v252, 4, 1
    s_waitcnt lgkmcnt(12)
    v_mfma_f32_32x32x16_bf16 v[192:207], v[148:151], v[36:39], v[192:207]
    ds_read_b64_tr_b16 v[140:141], v243 offset:24704
    ds_read_b64_tr_b16 v[142:143], v243 offset:25472
    v_lshlrev_b32 v249, 2, v249
    v_and_b32 v239, 7, v252
    s_waitcnt lgkmcnt(11)
    v_mfma_f32_32x32x16_bf16 v[160:175], v[152:155], v[40:43], v[160:175]
    ds_read_b64_tr_b16 v[144:145], v240 offset:36864
    ds_read_b64_tr_b16 v[146:147], v240 offset:37632
    v_xor_b32 v239, v239, v249
    v_lshlrev_b32 v239, 4, v239
    s_waitcnt lgkmcnt(11)
    v_mfma_f32_32x32x16_bf16 v[176:191], v[156:159], v[40:43], v[176:191]
    ds_read_b64_tr_b16 v[148:149], v240 offset:36928
    ds_read_b64_tr_b16 v[150:151], v240 offset:37696
    v_lshrrev_b32 v249, 3, v252
    v_mul_u32_u24 v249, 1024, v249
    s_waitcnt lgkmcnt(10)
    v_mfma_f32_32x32x16_bf16 v[192:207], v[128:131], v[40:43], v[192:207]
    ds_read_b64_tr_b16 v[152:153], v240 offset:36992
    ds_read_b64_tr_b16 v[154:155], v240 offset:37760
    v_add_u32 v239, v239, v249
    s_waitcnt lgkmcnt(10)
    v_mfma_f32_32x32x16_bf16 v[160:175], v[132:135], v[44:47], v[160:175]
    ds_read_b64_tr_b16 v[156:157], v241 offset:36864
    ds_read_b64_tr_b16 v[158:159], v241 offset:37632
    s_waitcnt lgkmcnt(10)
    v_mfma_f32_32x32x16_bf16 v[176:191], v[136:139], v[44:47], v[176:191]
    ds_read_b64_tr_b16 v[128:129], v241 offset:36928
    ds_read_b64_tr_b16 v[130:131], v241 offset:37696
    s_waitcnt lgkmcnt(10)
    v_mfma_f32_32x32x16_bf16 v[192:207], v[140:143], v[44:47], v[192:207]
    ds_read_b64_tr_b16 v[132:133], v241 offset:36992
    ds_read_b64_tr_b16 v[134:135], v241 offset:37760
    s_waitcnt lgkmcnt(10)
    v_mfma_f32_32x32x16_bf16 v[160:175], v[144:147], v[48:51], v[160:175]
    s_barrier
    ds_read_b64_tr_b16 v[136:137], v242 offset:36864
    ds_read_b64_tr_b16 v[138:139], v242 offset:37632
    v_mfma_f32_16x16x32_bf16 v[0:3], v[244:247], v[144:147], v[0:3]
    s_waitcnt lgkmcnt(10)
    v_mfma_f32_32x32x16_bf16 v[176:191], v[148:151], v[48:51], v[176:191]
    ds_read_b64_tr_b16 v[140:141], v242 offset:36928
    ds_read_b64_tr_b16 v[142:143], v242 offset:37696
    v_mov_b64 v[210:211], 0
    v_mov_b64 v[214:215], 0
    v_mfma_f32_16x16x32_bf16 v[4:7], v[244:247], v[148:151], v[4:7]
    s_waitcnt lgkmcnt(10)
    v_mfma_f32_32x32x16_bf16 v[192:207], v[152:155], v[48:51], v[192:207]
    ds_read_b64_tr_b16 v[144:145], v242 offset:36992
    ds_read_b64_tr_b16 v[146:147], v242 offset:37760
    v_mov_b64 v[218:219], 0
    s_lshl_b32 s73, s69, 2
    v_mfma_f32_16x16x32_bf16 v[8:11], v[244:247], v[152:155], v[8:11]
    s_waitcnt lgkmcnt(10)
    v_mfma_f32_32x32x16_bf16 v[160:175], v[156:159], v[52:55], v[160:175]
    ds_read_b64_tr_b16 v[148:149], v243 offset:36864
    ds_read_b64_tr_b16 v[150:151], v243 offset:37632
    v_add_u32 v233, s73, v251
    s_add_u32 s73, s73, 160768
    s_waitcnt lgkmcnt(10)
    v_mfma_f32_32x32x16_bf16 v[176:191], v[128:131], v[52:55], v[176:191]
    ds_read_b64_tr_b16 v[152:153], v243 offset:36928
    ds_read_b64_tr_b16 v[154:155], v243 offset:37696
    v_mov_b32 v234, s73
    v_mov_b32 v232, 160768
    s_waitcnt lgkmcnt(10)
    v_mfma_f32_32x32x16_bf16 v[192:207], v[132:135], v[52:55], v[192:207]
    ds_read_b64_tr_b16 v[156:157], v243 offset:36992
    ds_read_b64_tr_b16 v[158:159], v243 offset:37760
    s_lshl_b32 s73, s10, 6
    v_lshlrev_b32 v249, 1, v254
    s_waitcnt lgkmcnt(10)
    v_mfma_f32_32x32x16_bf16 v[160:175], v[136:139], v[56:59], v[160:175]
    ds_read_b64_tr_b16 v[128:129], v240 offset:49152
    ds_read_b64_tr_b16 v[130:131], v240 offset:49920
    s_waitcnt lgkmcnt(10)
    v_mfma_f32_32x32x16_bf16 v[176:191], v[140:143], v[56:59], v[176:191]
    ds_read_b64_tr_b16 v[132:133], v240 offset:49216
    ds_read_b64_tr_b16 v[134:135], v240 offset:49984
    s_waitcnt lgkmcnt(10)
    v_mfma_f32_32x32x16_bf16 v[192:207], v[144:147], v[56:59], v[192:207]
    s_barrier
    s_setprio 3
    ds_read_b64_tr_b16 v[136:137], v240 offset:49280
    ds_read_b64_tr_b16 v[138:139], v240 offset:50048
    s_waitcnt lgkmcnt(10)
    v_mfma_f32_32x32x16_bf16 v[160:175], v[148:151], v[60:63], v[160:175]
    v_add_u32 v240, 4294885376, v240
    ds_read_b64_tr_b16 v[140:141], v240 offset:0
    ds_read_b64_tr_b16 v[142:143], v240 offset:768
    s_waitcnt lgkmcnt(10)
    v_mfma_f32_32x32x16_bf16 v[176:191], v[152:155], v[60:63], v[176:191]
    ds_read_b64_tr_b16 v[144:145], v240 offset:64
    ds_read_b64_tr_b16 v[146:147], v240 offset:832
    s_waitcnt lgkmcnt(10)
    v_mfma_f32_32x32x16_bf16 v[192:207], v[156:159], v[60:63], v[192:207]
    ds_read_b64_tr_b16 v[148:149], v240 offset:128
    ds_read_b64_tr_b16 v[150:151], v240 offset:896
    s_waitcnt lgkmcnt(10)
    v_mfma_f32_32x32x16_bf16 v[160:175], v[128:131], v[64:67], v[160:175]
    ds_read_b64_tr_b16 v[152:153], v240 offset:12288
    ds_read_b64_tr_b16 v[154:155], v240 offset:13056
    v_mov_b64 v[24:25], 0
    v_mov_b64 v[26:27], 0
    v_mfma_f32_16x16x32_bf16 v[0:3], v[244:247], v[128:131], v[0:3]
    s_waitcnt lgkmcnt(10)
    v_mfma_f32_32x32x16_bf16 v[176:191], v[132:135], v[64:67], v[176:191]
    ds_read_b64_tr_b16 v[156:157], v240 offset:12352
    ds_read_b64_tr_b16 v[158:159], v240 offset:13120
    v_mov_b64 v[28:29], 0
    v_mov_b64 v[30:31], 0
    v_mfma_f32_16x16x32_bf16 v[4:7], v[244:247], v[132:135], v[4:7]
    s_waitcnt lgkmcnt(10)
    v_mfma_f32_32x32x16_bf16 v[192:207], v[136:139], v[64:67], v[192:207]
    ds_read_b64_tr_b16 v[128:129], v240 offset:12416
    ds_read_b64_tr_b16 v[130:131], v240 offset:13184
    v_mov_b64 v[32:33], 0
    v_mov_b64 v[34:35], 0
    v_mfma_f32_16x16x32_bf16 v[8:11], v[244:247], v[136:139], v[8:11]
    s_waitcnt lgkmcnt(10)
    v_mfma_f32_32x32x16_bf16 v[160:175], v[140:143], v[80:83], v[160:175]
    ds_read_b64_tr_b16 v[132:133], v240 offset:24576
    ds_read_b64_tr_b16 v[134:135], v240 offset:25344
    buffer_load_ushort v64, v249, s[56:59], s73 offen offset:0
    buffer_load_ushort v65, v249, s[56:59], s73 offen offset:64
    buffer_load_ushort v66, v249, s[56:59], s73 offen offset:128
    v_mov_b64 v[36:37], 0
    v_mfma_f32_16x16x32_bf16 v[0:3], v[244:247], v[140:143], v[0:3]
    s_waitcnt lgkmcnt(10)
    v_mfma_f32_32x32x16_bf16 v[176:191], v[144:147], v[80:83], v[176:191]
    ds_read_b64_tr_b16 v[136:137], v240 offset:24640
    ds_read_b64_tr_b16 v[138:139], v240 offset:25408
    v_mov_b64 v[38:39], 0
    v_mov_b64 v[40:41], 0
    v_mfma_f32_16x16x32_bf16 v[4:7], v[244:247], v[144:147], v[4:7]
    s_waitcnt lgkmcnt(10)
    v_mfma_f32_32x32x16_bf16 v[192:207], v[148:151], v[80:83], v[192:207]
    ds_read_b64_tr_b16 v[140:141], v240 offset:24704
    ds_read_b64_tr_b16 v[142:143], v240 offset:25472
    v_mov_b64 v[42:43], 0
    v_mov_b64 v[44:45], 0
    v_mfma_f32_16x16x32_bf16 v[8:11], v[244:247], v[148:151], v[8:11]
    s_waitcnt lgkmcnt(10)
    v_mfma_f32_32x32x16_bf16 v[160:175], v[152:155], v[96:99], v[160:175]
    ds_read_b64_tr_b16 v[144:145], v241 offset:49152
    ds_read_b64_tr_b16 v[146:147], v241 offset:49920
    v_mov_b64 v[46:47], 0
    v_mov_b64 v[48:49], 0
    v_mfma_f32_16x16x32_bf16 v[0:3], v[244:247], v[152:155], v[0:3]
    s_waitcnt lgkmcnt(10)
    v_mfma_f32_32x32x16_bf16 v[176:191], v[156:159], v[96:99], v[176:191]
    ds_read_b64_tr_b16 v[148:149], v241 offset:49216
    ds_read_b64_tr_b16 v[150:151], v241 offset:49984
    v_mov_b64 v[50:51], 0
    v_mov_b64 v[52:53], 0
    v_mfma_f32_16x16x32_bf16 v[4:7], v[244:247], v[156:159], v[4:7]
    s_waitcnt lgkmcnt(10)
    v_mfma_f32_32x32x16_bf16 v[192:207], v[128:131], v[96:99], v[192:207]
    ds_read_b64_tr_b16 v[152:153], v241 offset:49280
    ds_read_b64_tr_b16 v[154:155], v241 offset:50048
    v_mov_b64 v[54:55], 0
    v_mov_b64 v[56:57], 0
    v_mfma_f32_16x16x32_bf16 v[8:11], v[244:247], v[128:131], v[8:11]
    s_waitcnt lgkmcnt(10)
    v_mfma_f32_32x32x16_bf16 v[160:175], v[132:135], v[112:115], v[160:175]
    ds_read_b64_tr_b16 v[156:157], v242 offset:49152
    ds_read_b64_tr_b16 v[158:159], v242 offset:49920
    v_mov_b64 v[58:59], 0
    v_mov_b64 v[60:61], 0
    v_mfma_f32_16x16x32_bf16 v[0:3], v[244:247], v[132:135], v[0:3]
    s_waitcnt lgkmcnt(10)
    v_mfma_f32_32x32x16_bf16 v[176:191], v[136:139], v[112:115], v[176:191]
    ds_read_b64_tr_b16 v[128:129], v242 offset:49216
    ds_read_b64_tr_b16 v[130:131], v242 offset:49984
    v_mov_b64 v[62:63], 0
    v_mfma_f32_16x16x32_bf16 v[4:7], v[244:247], v[136:139], v[4:7]
    s_waitcnt lgkmcnt(10)
    v_mfma_f32_32x32x16_bf16 v[192:207], v[140:143], v[112:115], v[192:207]
    ds_read_b64_tr_b16 v[132:133], v242 offset:49280
    ds_read_b64_tr_b16 v[134:135], v242 offset:50048
    v_mfma_f32_16x16x32_bf16 v[8:11], v[244:247], v[140:143], v[8:11]
    s_waitcnt lgkmcnt(10)
    v_mfma_f32_32x32x16_bf16 v[160:175], v[144:147], v[68:71], v[160:175]
    ds_read_b64_tr_b16 v[136:137], v243 offset:49152
    ds_read_b64_tr_b16 v[138:139], v243 offset:49920
    s_waitcnt lgkmcnt(10)
    v_mfma_f32_32x32x16_bf16 v[176:191], v[148:151], v[68:71], v[176:191]
    ds_read_b64_tr_b16 v[140:141], v243 offset:49216
    ds_read_b64_tr_b16 v[142:143], v243 offset:49984
    ds_write_b32 v233, v0 offset:512
    ds_write_b32 v233, v4 offset:1024
    ds_write_b32 v233, v8 offset:1536
L_pad1:
    s_cbranch_execz L_pad5
    s_waitcnt lgkmcnt(14)
    ds_write_b32 v234, v234
    s_waitcnt lgkmcnt(14)
    v_mfma_f32_32x32x16_bf16 v[192:207], v[152:155], v[68:71], v[192:207]
    s_waitcnt lgkmcnt(13)
    ds_read_b64_tr_b16 v[144:145], v243 offset:49280
    ds_read_b64_tr_b16 v[146:147], v243 offset:50048
    v_mov_b64 v[0:1], 0
    v_mov_b64 v[2:3], 0
    v_mov_b64 v[4:5], 0
    v_mov_b64 v[6:7], 0
    s_waitcnt lgkmcnt(14)
    v_mfma_f32_32x32x16_bf16 v[160:175], v[156:159], v[72:75], v[160:175]
    s_waitcnt lgkmcnt(13)
    v_add_u32 v241, 4294885376, v241
    ds_read_b64_tr_b16 v[148:149], v241 offset:0
    ds_read_b64_tr_b16 v[150:151], v241 offset:768
    v_mov_b64 v[8:9], 0
    s_waitcnt lgkmcnt(14)
    v_mfma_f32_32x32x16_bf16 v[176:191], v[128:131], v[72:75], v[176:191]
    s_waitcnt lgkmcnt(13)
    v_add_u32 v242, 4294885376, v242
    ds_read_b64_tr_b16 v[152:153], v242 offset:0
    ds_read_b64_tr_b16 v[154:155], v242 offset:768
    s_waitcnt lgkmcnt(11)
    ds_read_b128 v[80:83], v232
    ds_read_b128 v[12:15], v251 offset:512
    ds_read_b128 v[16:19], v251 offset:1024
    ds_read_b128 v[20:23], v251 offset:1536
    v_mov_b64 v[10:11], 0
    v_mfma_f32_32x32x16_bf16 v[192:207], v[132:135], v[72:75], v[192:207]
    s_waitcnt lgkmcnt(13)
    v_add_u32 v243, 4294885376, v243
    ds_read_b64_tr_b16 v[156:157], v243 offset:0
    ds_read_b64_tr_b16 v[158:159], v243 offset:768
    v_mfma_f32_32x32x16_bf16 v[160:175], v[136:139], v[76:79], v[160:175]
    s_waitcnt lgkmcnt(13)
    ds_read_b64_tr_b16 v[128:129], v241 offset:12288
    ds_read_b64_tr_b16 v[130:131], v241 offset:13056
    v_mfma_f32_32x32x16_bf16 v[176:191], v[140:143], v[76:79], v[176:191]
    s_waitcnt lgkmcnt(13)
    ds_read_b64_tr_b16 v[132:133], v242 offset:12288
    ds_read_b64_tr_b16 v[134:135], v242 offset:13056
    s_mov_b32 s79, 262144
    s_waitcnt vmcnt(0) lgkmcnt(6)
L_p3:
    v_min_u32 v80, v80, v81
    v_min3_u32 v80, v80, v82, v83
    v_cmp_eq_u32 vcc, 0, v80
    s_sub_u32 s79, s79, 1
    s_cmp_eq_u64 vcc, 0
    s_cbranch_scc1 L_p3d
    ds_read_b128 v[80:83], v232
    ds_read_b128 v[12:15], v251 offset:512
    ds_read_b128 v[16:19], v251 offset:1024
    ds_read_b128 v[20:23], v251 offset:1536
    s_waitcnt lgkmcnt(0)
    s_cmp_lg_u32 s79, 0
    s_cbranch_scc1 L_p3
L_p3d:
    v_lshlrev_b32 v64, 16, v64
    v_mfma_f32_32x32x16_bf16 v[192:207], v[144:147], v[76:79], v[192:207]
    ds_read_b64_tr_b16 v[136:137], v243 offset:12288
    ds_read_b64_tr_b16 v[138:139], v243 offset:13056
    v_add_f32 v12, v12, v13
    v_add_f32 v14, v14, v15
    v_add_f32 v12, v12, v14
    v_cvt_pk_bf16_f32 v249, v12, v12
    v_mfma_f32_32x32x16_bf16 v[160:175], v[148:151], v[84:87], v[160:175]
    ds_read_b64_tr_b16 v[140:141], v241 offset:24576
    ds_read_b64_tr_b16 v[142:143], v241 offset:25344
    v_lshlrev_b32 v249, 16, v249
    v_sub_f32 v249, v12, v249
    v_cvt_pk_bf16_f32 v208, v12, v249
    v_and_b32 v250, 0xffff0000, v208
    v_mfma_f32_32x32x16_bf16 v[160:175], v[152:155], v[88:91], v[160:175]
    ds_read_b64_tr_b16 v[144:145], v242 offset:24576
    ds_read_b64_tr_b16 v[146:147], v242 offset:25344
    v_sub_f32 v250, v249, v250
    v_cvt_pk_bf16_f32 v209, v250, v64
    v_mov_b64 v[12:13], 0
    v_mov_b64 v[14:15], 0
    s_waitcnt lgkmcnt(10)
    v_mfma_f32_32x32x16_bf16 v[160:175], v[156:159], v[92:95], v[160:175]
    ds_read_b64_tr_b16 v[148:149], v243 offset:24576
    ds_read_b64_tr_b16 v[150:151], v243 offset:25344
    v_mfma_f32_32x32x16_bf16 v[160:175], v[208:211], v[224:227], v[160:175]
    v_lshlrev_b32 v65, 16, v65
    v_add_f32 v16, v16, v17
    v_add_f32 v18, v18, v19
    s_waitcnt lgkmcnt(10)
    v_mfma_f32_32x32x16_bf16 v[160:175], v[128:131], v[100:103], v[160:175]
    ds_read_b64_tr_b16 v[152:153], v241 offset:64
    ds_read_b64_tr_b16 v[154:155], v241 offset:832
    v_add_f32 v16, v16, v18
    v_cvt_pk_bf16_f32 v249, v16, v16
    v_lshlrev_b32 v249, 16, v249
    v_sub_f32 v249, v16, v249
    s_waitcnt lgkmcnt(10)
    v_mfma_f32_32x32x16_bf16 v[160:175], v[132:135], v[104:107], v[160:175]
    ds_read_b64_tr_b16 v[156:157], v242 offset:64
    ds_read_b64_tr_b16 v[158:159], v242 offset:832
    v_cvt_pk_bf16_f32 v212, v16, v249
    v_and_b32 v250, 0xffff0000, v212
    v_sub_f32 v250, v249, v250
    v_cvt_pk_bf16_f32 v213, v250, v65
    s_waitcnt lgkmcnt(10)
    v_mfma_f32_32x32x16_bf16 v[160:175], v[136:139], v[108:111], v[160:175]
    ds_read_b64_tr_b16 v[128:129], v243 offset:64
    ds_read_b64_tr_b16 v[130:131], v243 offset:832
    v_mov_b64 v[16:17], 0
    v_mov_b64 v[18:19], 0
    v_mfma_f32_32x32x16_bf16 v[176:191], v[212:215], v[224:227], v[176:191]
    s_mov_b64 exec, 1
    v_mov_b32 v67, 0
    buffer_atomic_umax v67, off, s[52:55], s16 offset:48 sc0 sc1
    s_mov_b64 exec, -1
    s_waitcnt lgkmcnt(10)
    v_mfma_f32_32x32x16_bf16 v[160:175], v[140:143], v[116:119], v[160:175]
    ds_read_b64_tr_b16 v[132:133], v241 offset:12352
    ds_read_b64_tr_b16 v[134:135], v241 offset:13120
    v_lshlrev_b32 v66, 16, v66
    v_add_f32 v20, v20, v21
    v_add_f32 v22, v22, v23
    v_add_f32 v20, v20, v22
    s_waitcnt lgkmcnt(10)
    v_mfma_f32_32x32x16_bf16 v[160:175], v[144:147], v[120:123], v[160:175]
    ds_read_b64_tr_b16 v[136:137], v242 offset:12352
    ds_read_b64_tr_b16 v[138:139], v242 offset:13120
    v_cvt_pk_bf16_f32 v249, v20, v20
    v_lshlrev_b32 v249, 16, v249
    v_sub_f32 v249, v20, v249
    v_cvt_pk_bf16_f32 v216, v20, v249
    s_waitcnt lgkmcnt(10)
    v_mfma_f32_32x32x16_bf16 v[160:175], v[148:151], v[124:127], v[160:175]
    ds_read_b64_tr_b16 v[140:141], v243 offset:12352
    ds_read_b64_tr_b16 v[142:143], v243 offset:13120
    v_and_b32 v250, 0xffff0000, v216
    v_sub_f32 v250, v249, v250
    v_cvt_pk_bf16_f32 v217, v250, v66
    v_mov_b64 v[20:21], 0
    s_waitcnt lgkmcnt(10)
    v_mfma_f32_32x32x16_bf16 v[176:191], v[152:155], v[84:87], v[176:191]
    ds_read_b64_tr_b16 v[144:145], v241 offset:24640
    ds_read_b64_tr_b16 v[146:147], v241 offset:25408
    v_mov_b64 v[22:23], 0
    v_mfma_f32_32x32x16_bf16 v[192:207], v[216:219], v[224:227], v[192:207]
    s_waitcnt lgkmcnt(10)
    v_mfma_f32_32x32x16_bf16 v[176:191], v[156:159], v[88:91], v[176:191]
    ds_read_b64_tr_b16 v[148:149], v242 offset:24640
    ds_read_b64_tr_b16 v[150:151], v242 offset:25408
    s_waitcnt lgkmcnt(10)
    v_mfma_f32_32x32x16_bf16 v[176:191], v[128:131], v[92:95], v[176:191]
    ds_read_b64_tr_b16 v[152:153], v243 offset:24640
    ds_read_b64_tr_b16 v[154:155], v243 offset:25408
    v_max_f32 v160, 0, v160
    v_max_f32 v161, 0, v161
    v_max_f32 v162, 0, v162
    v_max_f32 v163, 0, v163
    s_waitcnt lgkmcnt(10)
    v_mfma_f32_32x32x16_bf16 v[176:191], v[132:135], v[100:103], v[176:191]
    ds_read_b64_tr_b16 v[156:157], v241 offset:128
    ds_read_b64_tr_b16 v[158:159], v241 offset:896
    v_max_f32 v164, 0, v164
    v_max_f32 v165, 0, v165
    v_max_f32 v166, 0, v166
    v_max_f32 v167, 0, v167
    s_waitcnt lgkmcnt(10)
    v_mfma_f32_32x32x16_bf16 v[176:191], v[136:139], v[104:107], v[176:191]
    ds_read_b64_tr_b16 v[128:129], v242 offset:128
    ds_read_b64_tr_b16 v[130:131], v242 offset:896
    v_mul_f32 v160, v160, v160
    v_mul_f32 v161, v161, v161
    v_mul_f32 v162, v162, v162
    v_mul_f32 v163, v163, v163
    s_waitcnt lgkmcnt(10)
    v_mfma_f32_32x32x16_bf16 v[176:191], v[140:143], v[108:111], v[176:191]
    ds_read_b64_tr_b16 v[132:133], v243 offset:128
    ds_read_b64_tr_b16 v[134:135], v243 offset:896
    v_mul_f32 v164, v164, v164
    v_mul_f32 v165, v165, v165
    v_mul_f32 v166, v166, v166
    v_mul_f32 v167, v167, v167
    s_waitcnt lgkmcnt(10)
    v_mfma_f32_32x32x16_bf16 v[176:191], v[144:147], v[116:119], v[176:191]
    ds_read_b64_tr_b16 v[136:137], v241 offset:12416
    ds_read_b64_tr_b16 v[138:139], v241 offset:13184
    v_cvt_pk_bf16_f32 v208, v160, v161
    v_cvt_pk_bf16_f32 v209, v162, v163
    v_cvt_pk_bf16_f32 v210, v164, v165
    v_cvt_pk_bf16_f32 v211, v166, v167
    s_waitcnt lgkmcnt(10)
    v_mfma_f32_32x32x16_bf16 v[176:191], v[148:151], v[120:123], v[176:191]
    ds_read_b64_tr_b16 v[140:141], v242 offset:12416
    ds_read_b64_tr_b16 v[142:143], v242 offset:13184
    v_max_f32 v168, 0, v168
    v_max_f32 v169, 0, v169
    v_max_f32 v170, 0, v170
    v_max_f32 v171, 0, v171
    s_waitcnt lgkmcnt(10)
    v_mfma_f32_32x32x16_bf16 v[176:191], v[152:155], v[124:127], v[176:191]
    ds_read_b64_tr_b16 v[144:145], v243 offset:12416
    ds_read_b64_tr_b16 v[146:147], v243 offset:13184
    v_max_f32 v172, 0, v172
    v_max_f32 v173, 0, v173
    v_max_f32 v174, 0, v174
    v_max_f32 v175, 0, v175
    s_waitcnt lgkmcnt(10)
    v_mfma_f32_32x32x16_bf16 v[192:207], v[156:159], v[84:87], v[192:207]
    ds_read_b64_tr_b16 v[148:149], v241 offset:24704
    ds_read_b64_tr_b16 v[150:151], v241 offset:25472
    v_mul_f32 v168, v168, v168
    v_mul_f32 v169, v169, v169
    v_mul_f32 v170, v170, v170
    v_mul_f32 v171, v171, v171
    s_waitcnt lgkmcnt(10)
    v_mfma_f32_32x32x16_bf16 v[192:207], v[128:131], v[88:91], v[192:207]
    ds_read_b64_tr_b16 v[152:153], v242 offset:24704
    ds_read_b64_tr_b16 v[154:155], v242 offset:25472
    v_mul_f32 v172, v172, v172
    v_mul_f32 v173, v173, v173
    v_mul_f32 v174, v174, v174
    v_mul_f32 v175, v175, v175
    s_waitcnt lgkmcnt(10)
    v_mfma_f32_32x32x16_bf16 v[192:207], v[132:135], v[92:95], v[192:207]
    ds_read_b64_tr_b16 v[156:157], v243 offset:24704
    ds_read_b64_tr_b16 v[158:159], v243 offset:25472
    v_cvt_pk_bf16_f32 v212, v168, v169
    v_cvt_pk_bf16_f32 v213, v170, v171
    v_cvt_pk_bf16_f32 v214, v172, v173
    v_cvt_pk_bf16_f32 v215, v174, v175
    s_waitcnt lgkmcnt(10)
    v_mfma_f32_32x32x16_bf16 v[192:207], v[136:139], v[100:103], v[192:207]
    v_max_f32 v176, 0, v176
    v_max_f32 v177, 0, v177
    v_max_f32 v178, 0, v178
    v_max_f32 v179, 0, v179
    v_max_f32 v180, 0, v180
    s_waitcnt lgkmcnt(8)
    v_mfma_f32_32x32x16_bf16 v[192:207], v[140:143], v[104:107], v[192:207]
    v_max_f32 v181, 0, v181
    v_max_f32 v182, 0, v182
    v_max_f32 v183, 0, v183
    v_mul_f32 v176, v176, v176
    v_mul_f32 v177, v177, v177
    s_waitcnt lgkmcnt(6)
    v_mfma_f32_32x32x16_bf16 v[192:207], v[144:147], v[108:111], v[192:207]
    v_mul_f32 v178, v178, v178
    v_mul_f32 v179, v179, v179
    v_mul_f32 v180, v180, v180
    v_mul_f32 v181, v181, v181
    v_mul_f32 v182, v182, v182
    s_waitcnt lgkmcnt(4)
    v_mfma_f32_32x32x16_bf16 v[192:207], v[148:151], v[116:119], v[192:207]
    v_mul_f32 v183, v183, v183
    v_cvt_pk_bf16_f32 v216, v176, v177
    v_cvt_pk_bf16_f32 v217, v178, v179
    v_cvt_pk_bf16_f32 v218, v180, v181
    v_cvt_pk_bf16_f32 v219, v182, v183
    s_waitcnt lgkmcnt(2)
    v_mfma_f32_32x32x16_bf16 v[192:207], v[152:155], v[120:123], v[192:207]
    v_max_f32 v184, 0, v184
    v_max_f32 v185, 0, v185
    v_max_f32 v186, 0, v186
    v_max_f32 v187, 0, v187
    v_max_f32 v188, 0, v188
    s_waitcnt lgkmcnt(0)
    v_mfma_f32_32x32x16_bf16 v[192:207], v[156:159], v[124:127], v[192:207]
    v_max_f32 v189, 0, v189
    v_max_f32 v190, 0, v190
    v_max_f32 v191, 0, v191
    v_mul_f32 v184, v184, v184
    v_mul_f32 v185, v185, v185
    s_setprio 3
    s_waitcnt vmcnt(0)
    s_mov_b64 exec, 1
    s_mov_b32 s79, 262144
    s_branch L_pollc3
L_poll3:
    buffer_atomic_umax v67, off, s[52:55], s16 offset:48 sc0 sc1
    s_waitcnt vmcnt(0)
L_pollc3:
    v_cmp_gt_u32 vcc, 32, v67
    s_nop 1
    s_cmp_eq_u64 vcc, 0
    s_cbranch_scc1 L_polld3
    s_sub_u32 s79, s79, 1
    s_cmp_lg_u32 s79, 0
    s_cbranch_scc1 L_poll3
L_polld3:
    s_mov_b64 exec, -1
    v_and_b32 v124, 27, v252
    v_cmp_eq_u32 vcc, 16, v124
    v_mov_b32 v125, 0x3f803f80
    s_nop 0
    v_cndmask_b32 v124, 0, v125, vcc
    v_cndmask_b32 v125, 0, v125, vcc
    v_mov_b64 v[126:127], v[124:125]
    v_mov_b64 v[128:129], v[124:125]
    v_mov_b64 v[130:131], v[124:125]
    v_mov_b64 v[132:133], v[124:125]
    v_mov_b64 v[134:135], v[124:125]
    v_mov_b64 v[136:137], v[124:125]
    v_mov_b64 v[138:139], v[124:125]
    v_mov_b64 v[140:141], v[124:125]
    v_mov_b64 v[142:143], v[124:125]
    v_mov_b64 v[144:145], v[124:125]
    v_mov_b64 v[146:147], v[124:125]
    v_mov_b64 v[232:233], v[124:125]
    buffer_load_dwordx4 v[112:115], v237, s[52:55], s5 offen sc1
    s_mov_b64 exec, s[26:27]
    buffer_load_dwordx4 v[124:127], v238, s[52:55], s5 offen offset:1024 sc1
    buffer_load_dwordx4 v[128:131], v238, s[52:55], s5 offen offset:1536 sc1
    s_mov_b64 exec, -1
    s_add_u32 s5, s5, 8192
    buffer_load_dwordx4 v[116:119], v237, s[52:55], s5 offen sc1
    s_mov_b64 exec, s[26:27]
    buffer_load_dwordx4 v[132:135], v238, s[52:55], s5 offen offset:1024 sc1
    buffer_load_dwordx4 v[136:139], v238, s[52:55], s5 offen offset:1536 sc1
    s_mov_b64 exec, -1
    s_add_u32 s5, s5, 8192
    buffer_load_dwordx4 v[120:123], v237, s[52:55], s5 offen sc1
    s_mov_b64 exec, s[26:27]
    buffer_load_dwordx4 v[140:143], v238, s[52:55], s5 offen offset:1024 sc1
    buffer_load_dwordx4 v[144:147], v238, s[52:55], s5 offen offset:1536 sc1
    s_mov_b64 exec, -1
    s_add_u32 s5, s5, 8192
    s_lshl_b32 s73, s68, 10
    s_add_u32 s73, s73, 147456
    v_lshl_add_u32 v244, v252, 4, s73
    ds_read_b128 v[96:99], v244
    v_xor_b32 v245, 1024, v244
    ds_read_b128 v[100:103], v245
    v_xor_b32 v246, 2048, v244
    ds_read_b128 v[104:107], v246
    v_xor_b32 v247, 3072, v244
    ds_read_b128 v[108:111], v247
    ds_write_b32 v234, v234 offset:16
    v_mul_f32 v186, v186, v186
    v_mul_f32 v187, v187, v187
    v_mul_f32 v188, v188, v188
    v_mul_f32 v189, v189, v189
    v_mul_f32 v190, v190, v190
    v_mul_f32 v191, v191, v191
    v_cvt_pk_bf16_f32 v220, v184, v185
    v_cvt_pk_bf16_f32 v221, v186, v187
    v_cvt_pk_bf16_f32 v222, v188, v189
    v_cvt_pk_bf16_f32 v223, v190, v191
    v_max_f32 v192, 0, v192
    v_max_f32 v193, 0, v193
    v_max_f32 v194, 0, v194
    v_max_f32 v195, 0, v195
    v_max_f32 v196, 0, v196
    v_max_f32 v197, 0, v197
    v_max_f32 v198, 0, v198
    v_max_f32 v199, 0, v199
    v_mul_f32 v192, v192, v192
    v_mul_f32 v193, v193, v193
    v_mul_f32 v194, v194, v194
    v_mul_f32 v195, v195, v195
    v_mul_f32 v196, v196, v196
    v_mul_f32 v197, v197, v197
    v_mul_f32 v198, v198, v198
    v_mul_f32 v199, v199, v199
    v_cvt_pk_bf16_f32 v224, v192, v193
    v_cvt_pk_bf16_f32 v225, v194, v195
    v_cvt_pk_bf16_f32 v226, v196, v197
    v_cvt_pk_bf16_f32 v227, v198, v199
    v_max_f32 v200, 0, v200
    v_max_f32 v201, 0, v201
    v_max_f32 v202, 0, v202
    v_max_f32 v203, 0, v203
    v_max_f32 v204, 0, v204
    v_max_f32 v205, 0, v205
    v_max_f32 v206, 0, v206
    v_max_f32 v207, 0, v207
    v_mul_f32 v200, v200, v200
    v_mul_f32 v201, v201, v201
    v_mul_f32 v202, v202, v202
    v_mul_f32 v203, v203, v203
    v_mul_f32 v204, v204, v204
    v_mul_f32 v205, v205, v205
    v_mul_f32 v206, v206, v206
    v_mul_f32 v207, v207, v207
    v_cvt_pk_bf16_f32 v228, v200, v201
    v_cvt_pk_bf16_f32 v229, v202, v203
    v_cvt_pk_bf16_f32 v230, v204, v205
    v_cvt_pk_bf16_f32 v231, v206, v207
    v_mov_b64 v[148:149], v[232:233]
    v_mov_b64 v[150:151], v[232:233]
    v_mov_b64 v[152:153], v[232:233]
    v_mov_b64 v[154:155], v[232:233]
    v_mov_b64 v[156:157], v[232:233]
    v_mov_b64 v[158:159], v[232:233]
    v_mov_b64 v[160:161], v[232:233]
    v_mov_b64 v[162:163], v[232:233]
    v_mov_b64 v[164:165], v[232:233]
    v_mov_b64 v[166:167], v[232:233]
    v_mov_b64 v[168:169], v[232:233]
    v_mov_b64 v[170:171], v[232:233]
    v_mov_b64 v[172:173], v[232:233]
    v_mov_b64 v[174:175], v[232:233]
    v_mov_b64 v[176:177], v[232:233]
    v_mov_b64 v[178:179], v[232:233]
    s_waitcnt lgkmcnt(0)
L_ATT:
L_pad2:
    s_cbranch_execz L_pad6
    s_waitcnt vmcnt(6)
    v_mfma_f32_32x32x16_bf16 v[64:79], v[112:115], v[100:103], 0
    s_nop 11
    v_exp_f32 v64, v64
    v_exp_f32 v65, v65
    v_exp_f32 v66, v66
    v_exp_f32 v67, v67
    v_exp_f32 v68, v68
    v_mfma_f32_32x32x16_bf16 v[80:95], v[112:115], v[104:107], 0
    v_exp_f32 v69, v69
    v_exp_f32 v70, v70
    v_exp_f32 v71, v71
    v_exp_f32 v72, v72
    v_exp_f32 v73, v73
    v_exp_f32 v74, v74
    v_smfmac_f32_32x32x32_bf16 v[16:31], v[124:127], v[64:71], v236
    buffer_load_dwordx4 v[180:183], v237, s[52:55], s5 offen sc1
    s_mov_b64 exec, s[26:27]
    buffer_load_dwordx4 v[148:151], v238, s[52:55], s5 offen offset:1024 sc1
    buffer_load_dwordx4 v[152:155], v238, s[52:55], s5 offen offset:1536 sc1
    s_mov_b64 exec, -1
    s_add_u32 s5, s5, 8192
    v_exp_f32 v75, v75
    v_exp_f32 v76, v76
    v_exp_f32 v77, v77
    v_exp_f32 v78, v78
    v_exp_f32 v79, v79
    v_exp_f32 v80, v80
    v_exp_f32 v81, v81
    v_smfmac_f32_32x32x32_bf16 v[16:31], v[128:131], v[72:79], v236
    v_exp_f32 v82, v82
    v_exp_f32 v83, v83
    v_exp_f32 v84, v84
    v_mfma_f32_32x32x16_bf16 v[64:79], v[112:115], v[108:111], 0
    v_exp_f32 v85, v85
    v_exp_f32 v86, v86
    v_exp_f32 v87, v87
    v_exp_f32 v88, v88
    v_exp_f32 v89, v89
    v_exp_f32 v90, v90
    v_smfmac_f32_32x32x32_bf16 v[32:47], v[124:127], v[80:87], v236
    buffer_load_dwordx4 v[184:187], v237, s[52:55], s5 offen sc1
    s_mov_b64 exec, s[26:27]
    buffer_load_dwordx4 v[156:159], v238, s[52:55], s5 offen offset:1024 sc1
    buffer_load_dwordx4 v[160:163], v238, s[52:55], s5 offen offset:1536 sc1
    s_mov_b64 exec, -1
    s_add_u32 s5, s5, 8192
    v_exp_f32 v91, v91
    v_exp_f32 v92, v92
    v_exp_f32 v93, v93
    v_exp_f32 v94, v94
    v_exp_f32 v95, v95
    v_exp_f32 v64, v64
    v_exp_f32 v65, v65
    v_smfmac_f32_32x32x32_bf16 v[32:47], v[128:131], v[88:95], v236
    v_exp_f32 v66, v66
    v_exp_f32 v67, v67
    v_exp_f32 v68, v68
    v_mfma_f32_32x32x16_bf16 v[80:95], v[112:115], v[96:99], 0
    v_exp_f32 v69, v69
    v_exp_f32 v70, v70
    v_exp_f32 v71, v71
    v_exp_f32 v72, v72
    v_exp_f32 v73, v73
    v_exp_f32 v74, v74
    v_smfmac_f32_32x32x32_bf16 v[48:63], v[124:127], v[64:71], v236
    buffer_load_dwordx4 v[188:191], v237, s[52:55], s5 offen sc1
    s_mov_b64 exec, s[26:27]
    buffer_load_dwordx4 v[164:167], v238, s[52:55], s5 offen offset:1024 sc1
    buffer_load_dwordx4 v[168:171], v238, s[52:55], s5 offen offset:1536 sc1
    s_mov_b64 exec, -1
    s_add_u32 s5, s5, 8192
    v_exp_f32 v75, v75
    v_exp_f32 v76, v76
    v_exp_f32 v77, v77
    v_exp_f32 v78, v78
    v_exp_f32 v79, v79
    v_exp_f32 v80, v80
    v_exp_f32 v81, v81
    v_smfmac_f32_32x32x32_bf16 v[48:63], v[128:131], v[72:79], v236
    s_waitcnt vmcnt(12)
    v_exp_f32 v82, v82
    v_exp_f32 v83, v83
    v_exp_f32 v84, v84
    v_mfma_f32_32x32x16_bf16 v[64:79], v[116:119], v[100:103], 0
    v_exp_f32 v85, v85
    v_exp_f32 v86, v86
    v_exp_f32 v87, v87
    v_exp_f32 v88, v88
    v_exp_f32 v89, v89
    v_exp_f32 v90, v90
    v_smfmac_f32_32x32x32_bf16 v[0:15], v[124:127], v[80:87], v236
    buffer_load_dwordx4 v[192:195], v237, s[52:55], s5 offen sc1
    s_mov_b64 exec, s[26:27]
    buffer_load_dwordx4 v[172:175], v238, s[52:55], s5 offen offset:1024 sc1
    buffer_load_dwordx4 v[176:179], v238, s[52:55], s5 offen offset:1536 sc1
    s_mov_b64 exec, -1
    s_add_u32 s5, s5, 8192
    v_exp_f32 v91, v91
    v_exp_f32 v92, v92
    v_exp_f32 v93, v93
    v_exp_f32 v94, v94
    v_exp_f32 v95, v95
    v_exp_f32 v64, v64
    v_exp_f32 v65, v65
    v_smfmac_f32_32x32x32_bf16 v[0:15], v[128:131], v[88:95], v236
    buffer_load_dwordx4 v[112:115], v237, s[52:55], s5 offen sc1
    s_mov_b64 exec, s[26:27]
    buffer_load_dwordx4 v[124:127], v238, s[52:55], s5 offen offset:1024 sc1
    buffer_load_dwordx4 v[128:131], v238, s[52:55], s5 offen offset:1536 sc1
    s_mov_b64 exec, -1
    v_exp_f32 v66, v66
    v_exp_f32 v67, v67
    v_exp_f32 v68, v68
    v_mfma_f32_32x32x16_bf16 v[80:95], v[116:119], v[104:107], 0
    s_add_u32 s5, s5, 8192
    v_exp_f32 v69, v69
    v_exp_f32 v70, v70
    v_exp_f32 v71, v71
    v_exp_f32 v72, v72
    v_exp_f32 v73, v73
    v_exp_f32 v74, v74
    v_smfmac_f32_32x32x32_bf16 v[16:31], v[132:135], v[64:71], v236
    buffer_store_dwordx4 v[208:211], v237, s[52:55], s17 offen offset:0 sc1
    v_exp_f32 v75, v75
    v_exp_f32 v76, v76
    v_exp_f32 v77, v77
    v_exp_f32 v78, v78
    v_exp_f32 v79, v79
    v_exp_f32 v80, v80
    v_exp_f32 v81, v81
    v_smfmac_f32_32x32x32_bf16 v[16:31], v[136:139], v[72:79], v236
    v_exp_f32 v82, v82
    v_exp_f32 v83, v83
    v_exp_f32 v84, v84
    v_mfma_f32_32x32x16_bf16 v[64:79], v[116:119], v[108:111], 0
    v_exp_f32 v85, v85
    v_exp_f32 v86, v86
    v_exp_f32 v87, v87
    v_exp_f32 v88, v88
    v_exp_f32 v89, v89
    v_exp_f32 v90, v90
    v_smfmac_f32_32x32x32_bf16 v[32:47], v[132:135], v[80:87], v236
    buffer_store_dwordx4 v[212:215], v237, s[52:55], s17 offen offset:1024 sc1
    v_exp_f32 v91, v91
    v_exp_f32 v92, v92
    v_exp_f32 v93, v93
    v_exp_f32 v94, v94
    v_exp_f32 v95, v95
    v_exp_f32 v64, v64
    v_exp_f32 v65, v65
    v_smfmac_f32_32x32x32_bf16 v[32:47], v[136:139], v[88:95], v236
    v_exp_f32 v66, v66
    v_exp_f32 v67, v67
    v_exp_f32 v68, v68
    v_mfma_f32_32x32x16_bf16 v[80:95], v[116:119], v[96:99], 0
    v_exp_f32 v69, v69
    v_exp_f32 v70, v70
    v_exp_f32 v71, v71
    v_exp_f32 v72, v72
    v_exp_f32 v73, v73
    v_exp_f32 v74, v74
    v_smfmac_f32_32x32x32_bf16 v[48:63], v[132:135], v[64:71], v236
    buffer_store_dwordx4 v[216:219], v237, s[52:55], s24 offen offset:0 sc1
    v_exp_f32 v75, v75
    v_exp_f32 v76, v76
    v_exp_f32 v77, v77
    v_exp_f32 v78, v78
    v_exp_f32 v79, v79
    v_exp_f32 v80, v80
    v_exp_f32 v81, v81
    v_smfmac_f32_32x32x32_bf16 v[48:63], v[136:139], v[72:79], v236
    s_waitcnt vmcnt(18)
    v_exp_f32 v82, v82
    v_exp_f32 v83, v83
    v_exp_f32 v84, v84
    v_mfma_f32_32x32x16_bf16 v[64:79], v[120:123], v[100:103], 0
    v_exp_f32 v85, v85
    v_exp_f32 v86, v86
    v_exp_f32 v87, v87
    v_exp_f32 v88, v88
    v_exp_f32 v89, v89
    v_exp_f32 v90, v90
    v_smfmac_f32_32x32x32_bf16 v[0:15], v[132:135], v[80:87], v236
    buffer_store_dwordx4 v[220:223], v237, s[52:55], s24 offen offset:1024 sc1
    v_exp_f32 v91, v91
    v_exp_f32 v92, v92
    v_exp_f32 v93, v93
    v_exp_f32 v94, v94
    v_exp_f32 v95, v95
    v_exp_f32 v64, v64
    v_exp_f32 v65, v65
    v_smfmac_f32_32x32x32_bf16 v[0:15], v[136:139], v[88:95], v236
    buffer_load_dwordx4 v[116:119], v237, s[52:55], s5 offen sc1
    s_mov_b64 exec, s[26:27]
    buffer_load_dwordx4 v[132:135], v238, s[52:55], s5 offen offset:1024 sc1
    buffer_load_dwordx4 v[136:139], v238, s[52:55], s5 offen offset:1536 sc1
    s_mov_b64 exec, -1
    v_exp_f32 v66, v66
    v_exp_f32 v67, v67
    v_exp_f32 v68, v68
    v_mfma_f32_32x32x16_bf16 v[80:95], v[120:123], v[104:107], 0
    s_add_u32 s5, s5, 8192
    v_exp_f32 v69, v69
    v_exp_f32 v70, v70
    v_exp_f32 v71, v71
    v_exp_f32 v72, v72
    v_exp_f32 v73, v73
    v_exp_f32 v74, v74
    v_smfmac_f32_32x32x32_bf16 v[16:31], v[140:143], v[64:71], v236
    buffer_store_dwordx4 v[224:227], v237, s[52:55], s24 offen offset:2048 sc1
    v_exp_f32 v75, v75
    v_exp_f32 v76, v76
    v_exp_f32 v77, v77
    v_exp_f32 v78, v78
    v_exp_f32 v79, v79
    v_exp_f32 v80, v80
    v_exp_f32 v81, v81
    v_smfmac_f32_32x32x32_bf16 v[16:31], v[144:147], v[72:79], v236
    v_exp_f32 v82, v82
    v_exp_f32 v83, v83
    v_exp_f32 v84, v84
    v_mfma_f32_32x32x16_bf16 v[64:79], v[120:123], v[108:111], 0
    v_exp_f32 v85, v85
    v_exp_f32 v86, v86
    v_exp_f32 v87, v87
    v_exp_f32 v88, v88
    v_exp_f32 v89, v89
    v_exp_f32 v90, v90
    v_smfmac_f32_32x32x32_bf16 v[32:47], v[140:143], v[80:87], v236
    buffer_store_dwordx4 v[228:231], v237, s[52:55], s24 offen offset:3072 sc1
    v_exp_f32 v91, v91
    v_exp_f32 v92, v92
    v_exp_f32 v93, v93
    v_exp_f32 v94, v94
    v_exp_f32 v95, v95
    v_exp_f32 v64, v64
    v_exp_f32 v65, v65
    v_smfmac_f32_32x32x32_bf16 v[32:47], v[144:147], v[88:95], v236
    v_exp_f32 v66, v66
    v_exp_f32 v67, v67
    v_exp_f32 v68, v68
    v_mfma_f32_32x32x16_bf16 v[80:95], v[120:123], v[96:99], 0
    v_exp_f32 v69, v69
    v_exp_f32 v70, v70
    v_exp_f32 v71, v71
    v_exp_f32 v72, v72
    v_exp_f32 v73, v73
    v_exp_f32 v74, v74
    v_smfmac_f32_32x32x32_bf16 v[48:63], v[140:143], v[64:71], v236
    v_exp_f32 v75, v75
    v_exp_f32 v76, v76
    v_exp_f32 v77, v77
    v_exp_f32 v78, v78
    v_exp_f32 v79, v79
    v_exp_f32 v80, v80
    v_exp_f32 v81, v81
    v_smfmac_f32_32x32x32_bf16 v[48:63], v[144:147], v[72:79], v236
    s_waitcnt vmcnt(21)
    v_exp_f32 v82, v82
    v_exp_f32 v83, v83
    v_exp_f32 v84, v84
    v_mfma_f32_32x32x16_bf16 v[64:79], v[180:183], v[100:103], 0
    v_exp_f32 v85, v85
    v_exp_f32 v86, v86
    v_exp_f32 v87, v87
    v_exp_f32 v88, v88
    v_exp_f32 v89, v89
    v_exp_f32 v90, v90
    v_smfmac_f32_32x32x32_bf16 v[0:15], v[140:143], v[80:87], v236
    v_exp_f32 v91, v91
    v_exp_f32 v92, v92
    v_exp_f32 v93, v93
    v_exp_f32 v94, v94
    v_exp_f32 v95, v95
    v_exp_f32 v64, v64
    v_exp_f32 v65, v65
    v_smfmac_f32_32x32x32_bf16 v[0:15], v[144:147], v[88:95], v236
    buffer_load_dwordx4 v[120:123], v237, s[52:55], s5 offen sc1
    s_mov_b64 exec, s[26:27]
    buffer_load_dwordx4 v[140:143], v238, s[52:55], s5 offen offset:1024 sc1
    buffer_load_dwordx4 v[144:147], v238, s[52:55], s5 offen offset:1536 sc1
    s_mov_b64 exec, -1
    v_exp_f32 v66, v66
    v_exp_f32 v67, v67
    v_exp_f32 v68, v68
    v_mfma_f32_32x32x16_bf16 v[80:95], v[180:183], v[104:107], 0
    s_add_u32 s5, s5, 8192
    v_exp_f32 v69, v69
    v_exp_f32 v70, v70
    v_exp_f32 v71, v71
    v_exp_f32 v72, v72
    v_exp_f32 v73, v73
    v_exp_f32 v74, v74
    v_smfmac_f32_32x32x32_bf16 v[16:31], v[148:151], v[64:71], v236
    v_exp_f32 v75, v75
    v_exp_f32 v76, v76
    v_exp_f32 v77, v77
    v_exp_f32 v78, v78
    v_exp_f32 v79, v79
    v_exp_f32 v80, v80
    v_exp_f32 v81, v81
    v_smfmac_f32_32x32x32_bf16 v[16:31], v[152:155], v[72:79], v236
    v_exp_f32 v82, v82
    v_exp_f32 v83, v83
    v_exp_f32 v84, v84
    v_mfma_f32_32x32x16_bf16 v[64:79], v[180:183], v[108:111], 0
    v_exp_f32 v85, v85
    v_exp_f32 v86, v86
    v_exp_f32 v87, v87
    v_exp_f32 v88, v88
    v_exp_f32 v89, v89
    v_exp_f32 v90, v90
    v_smfmac_f32_32x32x32_bf16 v[32:47], v[148:151], v[80:87], v236
    v_exp_f32 v91, v91
    v_exp_f32 v92, v92
    v_exp_f32 v93, v93
    v_exp_f32 v94, v94
    v_exp_f32 v95, v95
    v_exp_f32 v64, v64
    v_exp_f32 v65, v65
    v_smfmac_f32_32x32x32_bf16 v[32:47], v[152:155], v[88:95], v236
    v_exp_f32 v66, v66
    v_exp_f32 v67, v67
    v_exp_f32 v68, v68
    v_mfma_f32_32x32x16_bf16 v[80:95], v[180:183], v[96:99], 0
    s_lshr_b32 s73, s70, 2
    s_and_b32 s74, s71, 1
    s_lshl1_add_u32 s73, s73, s74
    s_and_b32 s74, s68, 1
    s_lshl1_add_u32 s73, s73, s74
    s_mul_i32 s73, s73, 22
    s_lshl4_add_u32 s73, s13, s73
    s_lshl_b32 s73, s73, 10
    s_and_b32 s74, s15, 0x3ff
    s_add_u32 s73, s73, s74
    v_lshlrev_b32 v240, 10, v252
    s_mov_b64 exec, 4194303
    buffer_load_dword v251, v240, s[44:47], s73 offen
    s_mov_b64 exec, -1
    v_exp_f32 v69, v69
    v_exp_f32 v70, v70
    v_exp_f32 v71, v71
    v_exp_f32 v72, v72
    v_exp_f32 v73, v73
    v_exp_f32 v74, v74
    v_smfmac_f32_32x32x32_bf16 v[48:63], v[148:151], v[64:71], v236
    v_exp_f32 v75, v75
    v_exp_f32 v76, v76
    v_exp_f32 v77, v77
    v_exp_f32 v78, v78
    v_exp_f32 v79, v79
    v_exp_f32 v80, v80
    v_exp_f32 v81, v81
    v_smfmac_f32_32x32x32_bf16 v[48:63], v[152:155], v[72:79], v236
    s_waitcnt vmcnt(22)
    v_exp_f32 v82, v82
    v_exp_f32 v83, v83
    v_exp_f32 v84, v84
    v_mfma_f32_32x32x16_bf16 v[64:79], v[184:187], v[100:103], 0
    v_exp_f32 v85, v85
    v_exp_f32 v86, v86
    v_exp_f32 v87, v87
    v_exp_f32 v88, v88
    v_exp_f32 v89, v89
    v_exp_f32 v90, v90
    v_smfmac_f32_32x32x32_bf16 v[0:15], v[148:151], v[80:87], v236
    v_exp_f32 v91, v91
L_pad3:
    s_cbranch_execz L_wret
    v_exp_f32 v92, v92
    v_exp_f32 v93, v93
    v_exp_f32 v94, v94
    v_exp_f32 v95, v95
    v_exp_f32 v64, v64
    v_exp_f32 v65, v65
    v_smfmac_f32_32x32x32_bf16 v[0:15], v[152:155], v[88:95], v236
    v_exp_f32 v66, v66
    v_exp_f32 v67, v67
    v_exp_f32 v68, v68
    v_mfma_f32_32x32x16_bf16 v[80:95], v[184:187], v[104:107], 0
    v_exp_f32 v69, v69
    v_exp_f32 v70, v70
    v_exp_f32 v71, v71
    v_exp_f32 v72, v72
    v_exp_f32 v73, v73
    v_exp_f32 v74, v74
    v_smfmac_f32_32x32x32_bf16 v[16:31], v[156:159], v[64:71], v236
    v_mov_b32 v240, 160768
    s_mov_b32 s79, 262144
L_mk:
    ds_read_b128 v[244:247], v240 offset:16
    s_waitcnt lgkmcnt(0)
    v_min_u32 v244, v244, v245
    v_min3_u32 v244, v244, v246, v247
    v_cmp_eq_u32 vcc, 0, v244
    s_sub_u32 s79, s79, 1
    s_cmp_eq_u64 vcc, 0
    s_cbranch_scc1 L_mkd
    s_cmp_lg_u32 s79, 0
    s_cbranch_scc1 L_mk
L_mkd:
    v_exp_f32 v75, v75
    v_exp_f32 v76, v76
    v_exp_f32 v77, v77
    v_exp_f32 v78, v78
    v_exp_f32 v79, v79
    v_exp_f32 v80, v80
    v_exp_f32 v81, v81
    v_smfmac_f32_32x32x32_bf16 v[16:31], v[160:163], v[72:79], v236
    v_exp_f32 v82, v82
    v_exp_f32 v83, v83
    v_exp_f32 v84, v84
    v_mfma_f32_32x32x16_bf16 v[64:79], v[184:187], v[108:111], 0
    v_exp_f32 v85, v85
    v_exp_f32 v86, v86
    v_exp_f32 v87, v87
    v_exp_f32 v88, v88
    v_exp_f32 v89, v89
    v_exp_f32 v90, v90
    v_smfmac_f32_32x32x32_bf16 v[32:47], v[156:159], v[80:87], v236
    s_add_u32 m0, s12, 0
    s_add_u32 s7, s7, 16384
    buffer_load_dwordx4 v239, s[44:47], s7 offen lds
    v_exp_f32 v91, v91
    v_exp_f32 v92, v92
    v_exp_f32 v93, v93
    v_exp_f32 v94, v94
    v_exp_f32 v95, v95
    v_exp_f32 v64, v64
    v_exp_f32 v65, v65
    v_smfmac_f32_32x32x32_bf16 v[32:47], v[160:163], v[88:95], v236
    v_exp_f32 v66, v66
    v_exp_f32 v67, v67
    v_exp_f32 v68, v68
    v_mfma_f32_32x32x16_bf16 v[80:95], v[184:187], v[96:99], 0
    v_exp_f32 v69, v69
    v_exp_f32 v70, v70
    v_exp_f32 v71, v71
    v_exp_f32 v72, v72
    v_exp_f32 v73, v73
    v_exp_f32 v74, v74
    v_smfmac_f32_32x32x32_bf16 v[48:63], v[156:159], v[64:71], v236
    s_add_u32 m0, s12, 8192
    s_add_u32 s7, s7, 16384
    buffer_load_dwordx4 v239, s[44:47], s7 offen lds
    v_exp_f32 v75, v75
    v_exp_f32 v76, v76
    v_exp_f32 v77, v77
    v_exp_f32 v78, v78
    v_exp_f32 v79, v79
    v_exp_f32 v80, v80
    v_exp_f32 v81, v81
    v_smfmac_f32_32x32x32_bf16 v[48:63], v[160:163], v[72:79], v236
    s_waitcnt vmcnt(21)
    v_exp_f32 v82, v82
    v_exp_f32 v83, v83
    v_exp_f32 v84, v84
    v_mfma_f32_32x32x16_bf16 v[64:79], v[188:191], v[100:103], 0
    s_cmp_lt_u32 s68, 4
    s_cbranch_scc1 L_nof2
    s_lshl2_add_u32 s73, s70, s69
    s_lshl_b32 s73, s73, 9
    s_add_u32 s73, s73, 11927552
    v_mov_b32 v244, 1
    v_lshlrev_b32 v240, 7, v252
    s_waitcnt vmcnt(6)
    s_mov_b64 exec, 15
    buffer_atomic_add v244, v240, s[52:55], s73 offen offset:52 sc1
    s_mov_b64 exec, -1
    s_setprio 2
L_nof2:
    v_exp_f32 v85, v85
    v_exp_f32 v86, v86
    v_exp_f32 v87, v87
    v_exp_f32 v88, v88
    v_exp_f32 v89, v89
    v_exp_f32 v90, v90
    v_smfmac_f32_32x32x32_bf16 v[0:15], v[156:159], v[80:87], v236
    s_add_u32 m0, s12, 16384
    s_add_u32 s7, s7, 16384
    buffer_load_dwordx4 v239, s[44:47], s7 offen lds
    v_exp_f32 v91, v91
    v_exp_f32 v92, v92
    v_exp_f32 v93, v93
    v_exp_f32 v94, v94
    v_exp_f32 v95, v95
    v_exp_f32 v64, v64
    v_exp_f32 v65, v65
    v_smfmac_f32_32x32x32_bf16 v[0:15], v[160:163], v[88:95], v236
    v_exp_f32 v66, v66
    v_exp_f32 v67, v67
    v_exp_f32 v68, v68
    v_mfma_f32_32x32x16_bf16 v[80:95], v[188:191], v[104:107], 0
    v_exp_f32 v69, v69
    v_exp_f32 v70, v70
    v_exp_f32 v71, v71
    v_exp_f32 v72, v72
    v_exp_f32 v73, v73
    v_exp_f32 v74, v74
    v_smfmac_f32_32x32x32_bf16 v[16:31], v[164:167], v[64:71], v236
    v_exp_f32 v75, v75
    v_exp_f32 v76, v76
    v_exp_f32 v77, v77
    v_exp_f32 v78, v78
    v_exp_f32 v79, v79
    v_exp_f32 v80, v80
    v_exp_f32 v81, v81
    v_smfmac_f32_32x32x32_bf16 v[16:31], v[168:171], v[72:79], v236
    v_exp_f32 v82, v82
    v_exp_f32 v83, v83
    v_exp_f32 v84, v84
    v_mfma_f32_32x32x16_bf16 v[64:79], v[188:191], v[108:111], 0
    v_exp_f32 v85, v85
    v_exp_f32 v86, v86
    v_exp_f32 v87, v87
    v_exp_f32 v88, v88
    v_exp_f32 v89, v89
    v_exp_f32 v90, v90
    v_smfmac_f32_32x32x32_bf16 v[32:47], v[164:167], v[80:87], v236
    s_add_u32 m0, s12, 24576
    s_add_u32 s7, s7, 16384
    buffer_load_dwordx4 v239, s[44:47], s7 offen lds
    v_exp_f32 v91, v91
    v_exp_f32 v92, v92
    v_exp_f32 v93, v93
    v_exp_f32 v94, v94
    v_exp_f32 v95, v95
    v_exp_f32 v64, v64
    v_exp_f32 v65, v65
    v_smfmac_f32_32x32x32_bf16 v[32:47], v[168:171], v[88:95], v236
    v_exp_f32 v66, v66
    v_exp_f32 v67, v67
    v_exp_f32 v68, v68
    v_mfma_f32_32x32x16_bf16 v[80:95], v[188:191], v[96:99], 0
    v_exp_f32 v69, v69
    v_exp_f32 v70, v70
    v_exp_f32 v71, v71
    v_exp_f32 v72, v72
    v_exp_f32 v73, v73
    v_exp_f32 v74, v74
    v_smfmac_f32_32x32x32_bf16 v[48:63], v[164:167], v[64:71], v236
    s_add_u32 m0, s12, 32768
    s_add_u32 s7, s7, 16384
    buffer_load_dwordx4 v239, s[44:47], s7 offen lds
    v_exp_f32 v75, v75
    v_exp_f32 v76, v76
    v_exp_f32 v77, v77
    v_exp_f32 v78, v78
    v_exp_f32 v79, v79
    v_exp_f32 v80, v80
    v_exp_f32 v81, v81
    v_smfmac_f32_32x32x32_bf16 v[48:63], v[168:171], v[72:79], v236
    s_waitcnt vmcnt(21)
    v_exp_f32 v82, v82
    v_exp_f32 v83, v83
    v_exp_f32 v84, v84
    v_mfma_f32_32x32x16_bf16 v[64:79], v[192:195], v[100:103], 0
    v_exp_f32 v85, v85
    v_exp_f32 v86, v86
    v_exp_f32 v87, v87
    v_exp_f32 v88, v88
    v_exp_f32 v89, v89
    v_exp_f32 v90, v90
    v_smfmac_f32_32x32x32_bf16 v[0:15], v[164:167], v[80:87], v236
    s_add_u32 m0, s12, 40960
    s_add_u32 s7, s7, 16384
    buffer_load_dwordx4 v239, s[44:47], s7 offen lds
    v_exp_f32 v91, v91
    v_exp_f32 v92, v92
    v_exp_f32 v93, v93
    v_exp_f32 v94, v94
    v_exp_f32 v95, v95
    v_exp_f32 v64, v64
    v_exp_f32 v65, v65
    v_smfmac_f32_32x32x32_bf16 v[0:15], v[168:171], v[88:95], v236
    v_exp_f32 v66, v66
    v_exp_f32 v67, v67
    v_exp_f32 v68, v68
    v_mfma_f32_32x32x16_bf16 v[80:95], v[192:195], v[104:107], 0
    v_exp_f32 v69, v69
    v_exp_f32 v70, v70
    v_exp_f32 v71, v71
    v_exp_f32 v72, v72
    v_exp_f32 v73, v73
    v_exp_f32 v74, v74
    v_smfmac_f32_32x32x32_bf16 v[16:31], v[172:175], v[64:71], v236
    v_exp_f32 v75, v75
    v_exp_f32 v76, v76
    v_exp_f32 v77, v77
    v_exp_f32 v78, v78
    v_exp_f32 v79, v79
    v_exp_f32 v80, v80
    v_exp_f32 v81, v81
    v_smfmac_f32_32x32x32_bf16 v[16:31], v[176:179], v[72:79], v236
    v_exp_f32 v82, v82
    v_exp_f32 v83, v83
    v_exp_f32 v84, v84
    v_mfma_f32_32x32x16_bf16 v[64:79], v[192:195], v[108:111], 0
    v_exp_f32 v85, v85
    v_exp_f32 v86, v86
    v_exp_f32 v87, v87
    v_exp_f32 v88, v88
    v_exp_f32 v89, v89
    v_exp_f32 v90, v90
    v_smfmac_f32_32x32x32_bf16 v[32:47], v[172:175], v[80:87], v236
    s_add_u32 m0, s12, 49152
    s_add_u32 s7, s7, 16384
    buffer_load_dwordx4 v239, s[44:47], s7 offen lds
    v_exp_f32 v91, v91
    v_exp_f32 v92, v92
    v_exp_f32 v93, v93
    v_exp_f32 v94, v94
    v_exp_f32 v95, v95
    v_exp_f32 v64, v64
    v_exp_f32 v65, v65
    v_smfmac_f32_32x32x32_bf16 v[32:47], v[176:179], v[88:95], v236
    v_exp_f32 v66, v66
    v_exp_f32 v67, v67
    v_exp_f32 v68, v68
    v_mfma_f32_32x32x16_bf16 v[80:95], v[192:195], v[96:99], 0
    v_exp_f32 v69, v69
    v_exp_f32 v70, v70
    v_exp_f32 v71, v71
    v_exp_f32 v72, v72
    v_exp_f32 v73, v73
    v_exp_f32 v74, v74
    v_smfmac_f32_32x32x32_bf16 v[48:63], v[172:175], v[64:71], v236
    s_add_u32 m0, s12, 57344
    s_add_u32 s7, s7, 16384
    buffer_load_dwordx4 v239, s[44:47], s7 offen lds
    v_exp_f32 v75, v75
    v_exp_f32 v76, v76
    v_exp_f32 v77, v77
    v_exp_f32 v78, v78
    v_exp_f32 v79, v79
    v_exp_f32 v80, v80
    v_exp_f32 v81, v81
    v_smfmac_f32_32x32x32_bf16 v[48:63], v[176:179], v[72:79], v236
    s_waitcnt vmcnt(21)
    v_exp_f32 v82, v82
    v_exp_f32 v83, v83
    v_exp_f32 v84, v84
    v_mfma_f32_32x32x16_bf16 v[64:79], v[112:115], v[100:103], 0
    s_lshr_b32 s77, s15, 16
    s_and_b32 s74, s68, 1
    s_lshl1_add_u32 s77, s77, s74
    s_bfe_u32 s74, s71, 0x20001
    s_lshl2_add_u32 s77, s77, s74
    s_lshl_b32 s77, s77, 7
    s_add_u32 s77, s77, 11927552
    v_mov_b32 v244, 0
    v_exp_f32 v85, v85
    v_exp_f32 v86, v86
    v_exp_f32 v87, v87
    v_exp_f32 v88, v88
    v_exp_f32 v89, v89
    v_exp_f32 v90, v90
    v_smfmac_f32_32x32x32_bf16 v[0:15], v[172:175], v[80:87], v236
    s_add_u32 m0, s12, 65536
    s_add_u32 s7, s7, 16384
    buffer_load_dwordx4 v239, s[44:47], s7 offen lds
    v_exp_f32 v91, v91
    v_exp_f32 v92, v92
    v_exp_f32 v93, v93
    v_exp_f32 v94, v94
    v_exp_f32 v95, v95
    v_exp_f32 v64, v64
    v_exp_f32 v65, v65
    v_smfmac_f32_32x32x32_bf16 v[0:15], v[176:179], v[88:95], v236
    v_exp_f32 v66, v66
    v_exp_f32 v67, v67
    v_exp_f32 v68, v68
    v_mfma_f32_32x32x16_bf16 v[80:95], v[112:115], v[104:107], 0
    v_exp_f32 v69, v69
    v_exp_f32 v70, v70
    v_exp_f32 v71, v71
    v_exp_f32 v72, v72
    v_exp_f32 v73, v73
    v_exp_f32 v74, v74
    v_smfmac_f32_32x32x32_bf16 v[16:31], v[124:127], v[64:71], v236
    s_mov_b64 exec, 1
    buffer_atomic_umax v244, off, s[52:55], s77 offset:52 sc0 sc1
    s_mov_b64 exec, -1
    v_exp_f32 v75, v75
    v_exp_f32 v76, v76
    v_exp_f32 v77, v77
    v_exp_f32 v78, v78
    v_exp_f32 v79, v79
    v_exp_f32 v80, v80
    v_exp_f32 v81, v81
    v_smfmac_f32_32x32x32_bf16 v[16:31], v[128:131], v[72:79], v236
    v_bfe_u32 v240, v252, 2, 2
    v_mad_u32_u24 v240, v253, 4, v240
    v_mul_u32_u24 v240, 128, v240
    v_add_u32 v241, v240, v255
    v_bfe_u32 v240, v252, 3, 1
    v_lshl_add_u32 v241, v240, 6, v241
    v_xor_b32 v242, 64, v241
    s_mul_i32 s19, s68, 7168
    s_add_u32 s19, s19, 98304
    v_add_u32 v243, s19, v241
    v_add_u32 v248, s19, v242
    s_lshl_b32 s18, s13, 14
    s_and_b32 s74, s15, 0x3ff
    s_add_u32 s18, s18, s74
    s_sub_u32 s18, s18, 16384
    s_lshl_b32 s74, s13, 10
    s_add_u32 s13, s6, 86016
    s_add_u32 s6, s6, s74
    v_exp_f32 v82, v82
    v_exp_f32 v83, v83
    v_exp_f32 v84, v84
    v_mfma_f32_32x32x16_bf16 v[64:79], v[112:115], v[108:111], 0
    v_exp_f32 v85, v85
    v_exp_f32 v86, v86
    v_exp_f32 v87, v87
    v_exp_f32 v88, v88
    v_exp_f32 v89, v89
    v_exp_f32 v90, v90
    v_smfmac_f32_32x32x32_bf16 v[32:47], v[124:127], v[80:87], v236
    s_add_u32 m0, s12, 73728
    s_add_u32 s7, s7, 16384
    buffer_load_dwordx4 v239, s[44:47], s7 offen lds
    v_exp_f32 v91, v91
    v_exp_f32 v92, v92
    v_exp_f32 v93, v93
    v_exp_f32 v94, v94
    v_exp_f32 v95, v95
    v_exp_f32 v64, v64
    v_exp_f32 v65, v65
    v_smfmac_f32_32x32x32_bf16 v[32:47], v[128:131], v[88:95], v236
    s_and_b32 s74, s71, 1
    s_lshl3_add_u32 s74, s74, s69
    s_lshl_b32 s74, s74, 5
    s_add_u32 s74, s74, 155648
    v_lshrrev_b32 v240, 3, v252
    v_lshl_add_u32 v240, v240, 2, s74
    ds_read_b32 v249, v240
    ds_read_b32 v250, v240 offset:128
    v_exp_f32 v66, v66
    v_exp_f32 v67, v67
    v_exp_f32 v68, v68
    v_mfma_f32_32x32x16_bf16 v[80:95], v[112:115], v[96:99], 0
    v_exp_f32 v69, v69
    v_exp_f32 v70, v70
    v_exp_f32 v71, v71
    v_exp_f32 v72, v72
    v_exp_f32 v73, v73
    v_exp_f32 v74, v74
    v_smfmac_f32_32x32x32_bf16 v[48:63], v[124:127], v[64:71], v236
    s_add_u32 m0, s12, 81920
    s_add_u32 s7, s7, 16384
    buffer_load_dwordx4 v239, s[44:47], s7 offen lds
    v_exp_f32 v75, v75
    v_exp_f32 v76, v76
    v_exp_f32 v77, v77
    v_exp_f32 v78, v78
    v_exp_f32 v79, v79
    v_exp_f32 v80, v80
    v_exp_f32 v81, v81
    v_smfmac_f32_32x32x32_bf16 v[48:63], v[128:131], v[72:79], v236
    s_waitcnt vmcnt(18)
    v_exp_f32 v82, v82
    v_exp_f32 v83, v83
    v_exp_f32 v84, v84
    v_mfma_f32_32x32x16_bf16 v[64:79], v[116:119], v[100:103], 0
    v_exp_f32 v85, v85
    v_exp_f32 v86, v86
    v_exp_f32 v87, v87
    v_exp_f32 v88, v88
    v_exp_f32 v89, v89
    v_exp_f32 v90, v90
    v_smfmac_f32_32x32x32_bf16 v[0:15], v[124:127], v[80:87], v236
    s_add_u32 m0, s12, 90112
    s_add_u32 s7, s7, 16384
    buffer_load_dwordx4 v239, s[44:47], s7 offen lds
    v_exp_f32 v91, v91
    v_exp_f32 v92, v92
    v_exp_f32 v93, v93
    v_exp_f32 v94, v94
    v_exp_f32 v95, v95
    v_exp_f32 v64, v64
    v_exp_f32 v65, v65
    v_smfmac_f32_32x32x32_bf16 v[0:15], v[128:131], v[88:95], v236
    buffer_load_dwordx4 v[112:115], v237, s[52:55], s5 offen sc1
    s_mov_b64 exec, s[26:27]
    buffer_load_dwordx4 v[124:127], v238, s[52:55], s5 offen offset:1024 sc1
    buffer_load_dwordx4 v[128:131], v238, s[52:55], s5 offen offset:1536 sc1
    s_mov_b64 exec, -1
    v_exp_f32 v66, v66
    v_exp_f32 v67, v67
    v_exp_f32 v68, v68
    v_mfma_f32_32x32x16_bf16 v[80:95], v[116:119], v[104:107], 0
    s_add_u32 s5, s5, 8192
    v_exp_f32 v69, v69
    v_exp_f32 v70, v70
    v_exp_f32 v71, v71
    v_exp_f32 v72, v72
    v_exp_f32 v73, v73
    v_exp_f32 v74, v74
    v_smfmac_f32_32x32x32_bf16 v[16:31], v[132:135], v[64:71], v236
    s_waitcnt vmcnt(6)
    s_mov_b64 exec, 1
    s_mov_b32 s79, 262144
    s_branch L_pollc4
L_poll4:
    buffer_atomic_umax v244, off, s[52:55], s77 offset:52 sc0 sc1
    s_waitcnt vmcnt(0)
L_pollc4:
    v_cmp_gt_u32 vcc, 16, v244
    s_nop 1
    s_cmp_eq_u64 vcc, 0
    s_cbranch_scc1 L_polld4
    s_sub_u32 s79, s79, 1
    s_cmp_lg_u32 s79, 0
    s_cbranch_scc1 L_poll4
L_polld4:
    s_mov_b64 exec, -1
    v_add_u32 v247, 7168, v239
    v_exp_f32 v75, v75
    v_exp_f32 v76, v76
    v_exp_f32 v77, v77
    v_exp_f32 v78, v78
    v_exp_f32 v79, v79
    v_exp_f32 v80, v80
    v_exp_f32 v81, v81
    v_smfmac_f32_32x32x32_bf16 v[16:31], v[136:139], v[72:79], v236
    s_add_u32 m0, s19, 0
    s_add_u32 s18, s18, 16384
    v_exp_f32 v82, v82
    v_exp_f32 v83, v83
    v_exp_f32 v84, v84
    v_mfma_f32_32x32x16_bf16 v[64:79], v[116:119], v[108:111], 0
    v_exp_f32 v85, v85
    v_exp_f32 v86, v86
    v_exp_f32 v87, v87
    v_exp_f32 v88, v88
    v_exp_f32 v89, v89
    v_exp_f32 v90, v90
    v_smfmac_f32_32x32x32_bf16 v[32:47], v[132:135], v[80:87], v236
    buffer_load_dwordx4 v239, s[44:47], s18 offen lds
    buffer_load_dwordx4 v247, s[44:47], s18 offen offset:1024 lds
    buffer_load_dwordx4 v[148:151], v237, s[52:55], s6 offen offset:0 sc1
    v_exp_f32 v91, v91
    v_exp_f32 v92, v92
    v_exp_f32 v93, v93
    v_exp_f32 v94, v94
    v_exp_f32 v95, v95
    v_exp_f32 v64, v64
    v_exp_f32 v65, v65
    v_smfmac_f32_32x32x32_bf16 v[32:47], v[136:139], v[88:95], v236
    v_exp_f32 v66, v66
    v_exp_f32 v67, v67
    v_exp_f32 v68, v68
    v_mfma_f32_32x32x16_bf16 v[80:95], v[116:119], v[96:99], 0
    v_exp_f32 v69, v69
    v_exp_f32 v70, v70
    v_exp_f32 v71, v71
    v_exp_f32 v72, v72
    v_exp_f32 v73, v73
    v_exp_f32 v74, v74
    v_smfmac_f32_32x32x32_bf16 v[48:63], v[132:135], v[64:71], v236
    buffer_load_dwordx4 v[152:155], v237, s[52:55], s6 offen offset:1024 sc1
    buffer_load_dwordx4 v[156:159], v237, s[52:55], s6 offen offset:2048 sc1
    buffer_load_dwordx4 v[160:163], v237, s[52:55], s6 offen offset:3072 sc1
    v_exp_f32 v75, v75
    v_exp_f32 v76, v76
    v_exp_f32 v77, v77
    v_exp_f32 v78, v78
    v_exp_f32 v79, v79
    v_exp_f32 v80, v80
    v_exp_f32 v81, v81
    v_smfmac_f32_32x32x32_bf16 v[48:63], v[136:139], v[72:79], v236
    s_add_u32 m0, s19, 2048
    s_add_u32 s18, s18, 16384
    v_exp_f32 v82, v82
    v_exp_f32 v83, v83
    v_exp_f32 v84, v84
    v_mfma_f32_32x32x16_bf16 v[64:79], v[120:123], v[100:103], 0
    s_add_u32 s6, s6, 4096
    v_exp_f32 v85, v85
    v_exp_f32 v86, v86
    v_exp_f32 v87, v87
    v_exp_f32 v88, v88
    v_exp_f32 v89, v89
    v_exp_f32 v90, v90
    v_smfmac_f32_32x32x32_bf16 v[0:15], v[132:135], v[80:87], v236
    buffer_load_dwordx4 v239, s[44:47], s18 offen lds
    buffer_load_dwordx4 v247, s[44:47], s18 offen offset:1024 lds
    buffer_load_dwordx4 v[164:167], v237, s[52:55], s6 offen offset:0 sc1
    v_exp_f32 v91, v91
    v_exp_f32 v92, v92
    v_exp_f32 v93, v93
    v_exp_f32 v94, v94
    v_exp_f32 v95, v95
    v_exp_f32 v64, v64
    v_exp_f32 v65, v65
    v_smfmac_f32_32x32x32_bf16 v[0:15], v[136:139], v[88:95], v236
    buffer_load_dwordx4 v[116:119], v237, s[52:55], s5 offen sc1
    s_mov_b64 exec, s[26:27]
    buffer_load_dwordx4 v[132:135], v238, s[52:55], s5 offen offset:1024 sc1
    buffer_load_dwordx4 v[136:139], v238, s[52:55], s5 offen offset:1536 sc1
    s_mov_b64 exec, -1
    v_exp_f32 v66, v66
    v_exp_f32 v67, v67
    v_exp_f32 v68, v68
    v_mfma_f32_32x32x16_bf16 v[80:95], v[120:123], v[104:107], 0
    s_add_u32 s5, s5, 8192
    v_exp_f32 v69, v69
    v_exp_f32 v70, v70
    v_exp_f32 v71, v71
    v_exp_f32 v72, v72
    v_exp_f32 v73, v73
    v_exp_f32 v74, v74
    v_smfmac_f32_32x32x32_bf16 v[16:31], v[140:143], v[64:71], v236
    buffer_load_dwordx4 v[168:171], v237, s[52:55], s6 offen offset:1024 sc1
    buffer_load_dwordx4 v[172:175], v237, s[52:55], s6 offen offset:2048 sc1
    buffer_load_dwordx4 v[176:179], v237, s[52:55], s6 offen offset:3072 sc1
    v_exp_f32 v75, v75
    v_exp_f32 v76, v76
    v_exp_f32 v77, v77
    v_exp_f32 v78, v78
    v_exp_f32 v79, v79
    v_exp_f32 v80, v80
    v_exp_f32 v81, v81
    v_smfmac_f32_32x32x32_bf16 v[16:31], v[144:147], v[72:79], v236
    s_add_u32 m0, s19, 4096
    s_add_u32 s18, s18, 16384
    v_exp_f32 v82, v82
    v_exp_f32 v83, v83
    v_exp_f32 v84, v84
    v_mfma_f32_32x32x16_bf16 v[64:79], v[120:123], v[108:111], 0
    s_add_u32 s6, s6, 4096
    v_exp_f32 v85, v85
    v_exp_f32 v86, v86
    v_exp_f32 v87, v87
    v_exp_f32 v88, v88
    v_exp_f32 v89, v89
    v_exp_f32 v90, v90
    v_smfmac_f32_32x32x32_bf16 v[32:47], v[140:143], v[80:87], v236
    buffer_load_dwordx4 v239, s[44:47], s18 offen lds
    buffer_load_dwordx4 v247, s[44:47], s18 offen offset:1024 lds
    buffer_load_dwordx4 v[180:183], v237, s[52:55], s6 offen offset:0 sc1
    v_exp_f32 v91, v91
    v_exp_f32 v92, v92
    v_exp_f32 v93, v93
    v_exp_f32 v94, v94
    v_exp_f32 v95, v95
    v_exp_f32 v64, v64
    v_exp_f32 v65, v65
    v_smfmac_f32_32x32x32_bf16 v[32:47], v[144:147], v[88:95], v236
    v_exp_f32 v66, v66
    v_exp_f32 v67, v67
    v_exp_f32 v68, v68
    v_mfma_f32_32x32x16_bf16 v[80:95], v[120:123], v[96:99], 0
    v_exp_f32 v69, v69
    v_exp_f32 v70, v70
    v_exp_f32 v71, v71
    v_exp_f32 v72, v72
    v_exp_f32 v73, v73
    v_exp_f32 v74, v74
    v_smfmac_f32_32x32x32_bf16 v[48:63], v[140:143], v[64:71], v236
    buffer_load_dwordx4 v[184:187], v237, s[52:55], s6 offen offset:1024 sc1
    buffer_load_dwordx4 v[188:191], v237, s[52:55], s6 offen offset:2048 sc1
    buffer_load_dwordx4 v[192:195], v237, s[52:55], s6 offen offset:3072 sc1
    v_exp_f32 v75, v75
    v_exp_f32 v76, v76
    v_exp_f32 v77, v77
    v_exp_f32 v78, v78
    v_exp_f32 v79, v79
    v_exp_f32 v80, v80
    v_exp_f32 v81, v81
    v_smfmac_f32_32x32x32_bf16 v[48:63], v[144:147], v[72:79], v236
    s_waitcnt vmcnt(21)
    v_exp_f32 v82, v82
    v_exp_f32 v83, v83
    v_exp_f32 v84, v84
    v_mfma_f32_32x32x16_bf16 v[64:79], v[112:115], v[100:103], 0
    s_add_u32 s6, s6, 4096
    v_exp_f32 v85, v85
    v_exp_f32 v86, v86
    v_exp_f32 v87, v87
    v_exp_f32 v88, v88
    v_exp_f32 v89, v89
    v_exp_f32 v90, v90
    v_smfmac_f32_32x32x32_bf16 v[0:15], v[140:143], v[80:87], v236
    s_waitcnt vmcnt(19)
    ds_read_b64_tr_b16 v[228:229], v243 offset:0
    ds_read_b64_tr_b16 v[230:231], v243 offset:1024
    v_exp_f32 v91, v91
    v_exp_f32 v92, v92
    v_exp_f32 v93, v93
    v_exp_f32 v94, v94
    v_exp_f32 v95, v95
    v_exp_f32 v64, v64
    v_exp_f32 v65, v65
    v_smfmac_f32_32x32x32_bf16 v[0:15], v[144:147], v[88:95], v236
    buffer_load_dwordx4 v[120:123], v237, s[52:55], s5 offen sc1
    s_mov_b64 exec, s[26:27]
    buffer_load_dwordx4 v[140:143], v238, s[52:55], s5 offen offset:1024 sc1
    buffer_load_dwordx4 v[144:147], v238, s[52:55], s5 offen offset:1536 sc1
    s_mov_b64 exec, -1
    v_exp_f32 v66, v66
    v_exp_f32 v67, v67
    v_exp_f32 v68, v68
    v_mfma_f32_32x32x16_bf16 v[80:95], v[112:115], v[104:107], 0
    s_add_u32 s5, s5, 8192
    v_exp_f32 v69, v69
    v_exp_f32 v70, v70
    v_exp_f32 v71, v71
    v_exp_f32 v72, v72
    v_exp_f32 v73, v73
    v_smfmac_f32_32x32x32_bf16 v[16:31], v[124:127], v[64:71], v236
    s_waitcnt vmcnt(21) lgkmcnt(0)
    s_add_u32 m0, s19, 0
    v_exp_f32 v74, v74
    v_exp_f32 v75, v75
    v_exp_f32 v76, v76
    v_exp_f32 v77, v77
    v_mfma_f32_32x32x16_bf16 v[196:211], v[228:231], v[148:151], 0
    ds_read_b64_tr_b16 v[232:233], v248 offset:0
    ds_read_b64_tr_b16 v[234:235], v248 offset:1024
    v_exp_f32 v78, v78
    v_exp_f32 v79, v79
    v_exp_f32 v80, v80
    v_exp_f32 v81, v81
    v_smfmac_f32_32x32x32_bf16 v[16:31], v[128:131], v[72:79], v236
    v_exp_f32 v82, v82
    v_exp_f32 v83, v83
    v_exp_f32 v84, v84
    v_mfma_f32_32x32x16_bf16 v[64:79], v[112:115], v[108:111], 0
    s_add_u32 s18, s18, 16384
    v_exp_f32 v85, v85
    v_exp_f32 v86, v86
    v_exp_f32 v87, v87
    v_exp_f32 v88, v88
    v_exp_f32 v89, v89
    v_smfmac_f32_32x32x32_bf16 v[32:47], v[124:127], v[80:87], v236
    s_waitcnt lgkmcnt(0)
    buffer_load_dwordx4 v239, s[44:47], s18 offen lds
    buffer_load_dwordx4 v247, s[44:47], s18 offen offset:1024 lds
    v_exp_f32 v90, v90
    v_exp_f32 v91, v91
    v_exp_f32 v92, v92
    v_exp_f32 v93, v93
    v_mfma_f32_32x32x16_bf16 v[212:227], v[232:235], v[148:151], 0
    s_waitcnt vmcnt(18)
    ds_read_b64_tr_b16 v[228:229], v243 offset:2048
    ds_read_b64_tr_b16 v[230:231], v243 offset:3072
    v_exp_f32 v94, v94
    v_exp_f32 v95, v95
    v_exp_f32 v64, v64
    v_exp_f32 v65, v65
    v_smfmac_f32_32x32x32_bf16 v[32:47], v[128:131], v[88:95], v236
    v_exp_f32 v66, v66
    v_exp_f32 v67, v67
    v_exp_f32 v68, v68
    v_mfma_f32_32x32x16_bf16 v[80:95], v[112:115], v[96:99], 0
    v_exp_f32 v69, v69
    v_exp_f32 v70, v70
    v_exp_f32 v71, v71
    v_exp_f32 v72, v72
    v_exp_f32 v73, v73
    v_smfmac_f32_32x32x32_bf16 v[48:63], v[124:127], v[64:71], v236
    s_waitcnt lgkmcnt(0)
    s_add_u32 m0, s19, 2048
    v_exp_f32 v74, v74
    v_exp_f32 v75, v75
    v_exp_f32 v76, v76
    v_exp_f32 v77, v77
    v_mfma_f32_32x32x16_bf16 v[196:211], v[228:231], v[152:155], v[196:211]
    ds_read_b64_tr_b16 v[232:233], v248 offset:2048
    ds_read_b64_tr_b16 v[234:235], v248 offset:3072
    v_exp_f32 v78, v78
    v_exp_f32 v79, v79
    v_exp_f32 v80, v80
    v_exp_f32 v81, v81
    v_smfmac_f32_32x32x32_bf16 v[48:63], v[128:131], v[72:79], v236
    s_waitcnt vmcnt(14)
    v_exp_f32 v82, v82
    v_exp_f32 v83, v83
    v_exp_f32 v84, v84
    v_mfma_f32_32x32x16_bf16 v[64:79], v[116:119], v[100:103], 0
    s_add_u32 s18, s18, 16384
    v_exp_f32 v85, v85
    v_exp_f32 v86, v86
    v_exp_f32 v87, v87
    v_exp_f32 v88, v88
    v_exp_f32 v89, v89
    v_smfmac_f32_32x32x32_bf16 v[0:15], v[124:127], v[80:87], v236
    s_waitcnt lgkmcnt(0)
    buffer_load_dwordx4 v239, s[44:47], s18 offen lds
    buffer_load_dwordx4 v247, s[44:47], s18 offen offset:1024 lds
    buffer_load_dwordx4 v[148:151], v237, s[52:55], s6 offen offset:0 sc1
    v_exp_f32 v90, v90
    v_exp_f32 v91, v91
    v_exp_f32 v92, v92
    v_exp_f32 v93, v93
    v_mfma_f32_32x32x16_bf16 v[212:227], v[232:235], v[152:155], v[212:227]
    s_waitcnt vmcnt(12)
    ds_read_b64_tr_b16 v[228:229], v243 offset:4096
    ds_read_b64_tr_b16 v[230:231], v243 offset:5120
    v_exp_f32 v94, v94
    v_exp_f32 v95, v95
    v_exp_f32 v64, v64
    v_exp_f32 v65, v65
    v_smfmac_f32_32x32x32_bf16 v[0:15], v[128:131], v[88:95], v236
    buffer_load_dwordx4 v[112:115], v237, s[52:55], s5 offen sc1
    s_mov_b64 exec, s[26:27]
    buffer_load_dwordx4 v[124:127], v238, s[52:55], s5 offen offset:1024 sc1
    buffer_load_dwordx4 v[128:131], v238, s[52:55], s5 offen offset:1536 sc1
    s_mov_b64 exec, -1
    v_exp_f32 v66, v66
    v_exp_f32 v67, v67
    v_exp_f32 v68, v68
    v_mfma_f32_32x32x16_bf16 v[80:95], v[116:119], v[104:107], 0
    s_add_u32 s5, s5, 8192
    v_exp_f32 v69, v69
    v_exp_f32 v70, v70
    v_exp_f32 v71, v71
    v_exp_f32 v72, v72
    v_exp_f32 v73, v73
    v_smfmac_f32_32x32x32_bf16 v[16:31], v[132:135], v[64:71], v236
    s_waitcnt lgkmcnt(0)
    s_add_u32 m0, s19, 4096
    v_exp_f32 v74, v74
    v_exp_f32 v75, v75
    v_exp_f32 v76, v76
    v_exp_f32 v77, v77
    v_mfma_f32_32x32x16_bf16 v[196:211], v[228:231], v[156:159], v[196:211]
    ds_read_b64_tr_b16 v[232:233], v248 offset:4096
    ds_read_b64_tr_b16 v[234:235], v248 offset:5120
    v_exp_f32 v78, v78
    v_exp_f32 v79, v79
    v_exp_f32 v80, v80
    v_exp_f32 v81, v81
    v_smfmac_f32_32x32x32_bf16 v[16:31], v[136:139], v[72:79], v236
    v_exp_f32 v82, v82
    v_exp_f32 v83, v83
    v_exp_f32 v84, v84
    v_mfma_f32_32x32x16_bf16 v[64:79], v[116:119], v[108:111], 0
    s_add_u32 s18, s18, 16384
    v_exp_f32 v85, v85
    v_exp_f32 v86, v86
    v_exp_f32 v87, v87
    v_exp_f32 v88, v88
    v_exp_f32 v89, v89
    v_smfmac_f32_32x32x32_bf16 v[32:47], v[132:135], v[80:87], v236
    s_waitcnt lgkmcnt(0)
    buffer_load_dwordx4 v239, s[44:47], s18 offen lds
    buffer_load_dwordx4 v247, s[44:47], s18 offen offset:1024 lds
    buffer_load_dwordx4 v[152:155], v237, s[52:55], s6 offen offset:1024 sc1
    v_exp_f32 v90, v90
    v_exp_f32 v91, v91
    v_exp_f32 v92, v92
    v_exp_f32 v93, v93
    v_mfma_f32_32x32x16_bf16 v[212:227], v[232:235], v[156:159], v[212:227]
    s_waitcnt vmcnt(9)
    ds_read_b64_tr_b16 v[228:229], v243 offset:0
    ds_read_b64_tr_b16 v[230:231], v243 offset:1024
    v_exp_f32 v94, v94
    v_exp_f32 v95, v95
    v_exp_f32 v64, v64
    v_exp_f32 v65, v65
    v_smfmac_f32_32x32x32_bf16 v[32:47], v[136:139], v[88:95], v236
    v_exp_f32 v66, v66
    v_exp_f32 v67, v67
    v_exp_f32 v68, v68
    v_mfma_f32_32x32x16_bf16 v[80:95], v[116:119], v[96:99], 0
    s_setprio 1
L_pad4:
    s_cbranch_execz L_wret
    v_exp_f32 v69, v69
    v_exp_f32 v70, v70
    v_exp_f32 v71, v71
    v_exp_f32 v72, v72
    v_exp_f32 v73, v73
    v_smfmac_f32_32x32x32_bf16 v[48:63], v[132:135], v[64:71], v236
    s_waitcnt lgkmcnt(0)
    s_add_u32 m0, s19, 0
    v_exp_f32 v74, v74
    v_exp_f32 v75, v75
    v_exp_f32 v76, v76
    v_exp_f32 v77, v77
    v_mfma_f32_32x32x16_bf16 v[196:211], v[228:231], v[160:163], v[196:211]
    ds_read_b64_tr_b16 v[232:233], v248 offset:0
    ds_read_b64_tr_b16 v[234:235], v248 offset:1024
    v_exp_f32 v78, v78
    v_exp_f32 v79, v79
    v_exp_f32 v80, v80
    v_exp_f32 v81, v81
    v_smfmac_f32_32x32x32_bf16 v[48:63], v[136:139], v[72:79], v236
    v_exp_f32 v82, v82
    v_exp_f32 v83, v83
    v_exp_f32 v84, v84
    v_mfma_f32_32x32x16_bf16 v[64:79], v[120:123], v[100:103], 0
    s_add_u32 s18, s18, 16384
    v_exp_f32 v85, v85
    v_exp_f32 v86, v86
    v_exp_f32 v87, v87
    v_exp_f32 v88, v88
    v_exp_f32 v89, v89
    v_smfmac_f32_32x32x32_bf16 v[0:15], v[132:135], v[80:87], v236
    s_waitcnt lgkmcnt(0)
    buffer_load_dwordx4 v239, s[44:47], s18 offen lds
    buffer_load_dwordx4 v247, s[44:47], s18 offen offset:1024 lds
    buffer_load_dwordx4 v[156:159], v237, s[52:55], s6 offen offset:2048 sc1
    v_exp_f32 v90, v90
    v_exp_f32 v91, v91
    v_exp_f32 v92, v92
    v_exp_f32 v93, v93
    v_mfma_f32_32x32x16_bf16 v[212:227], v[232:235], v[160:163], v[212:227]
    s_waitcnt vmcnt(10)
    ds_read_b64_tr_b16 v[228:229], v243 offset:2048
    ds_read_b64_tr_b16 v[230:231], v243 offset:3072
    v_exp_f32 v94, v94
    v_exp_f32 v95, v95
    v_exp_f32 v64, v64
    v_exp_f32 v65, v65
    v_smfmac_f32_32x32x32_bf16 v[0:15], v[136:139], v[88:95], v236
    buffer_load_dwordx4 v[116:119], v237, s[52:55], s5 offen sc1
    s_mov_b64 exec, s[26:27]
    buffer_load_dwordx4 v[132:135], v238, s[52:55], s5 offen offset:1024 sc1
    buffer_load_dwordx4 v[136:139], v238, s[52:55], s5 offen offset:1536 sc1
    s_mov_b64 exec, -1
    v_exp_f32 v66, v66
    v_exp_f32 v67, v67
    v_exp_f32 v68, v68
    v_mfma_f32_32x32x16_bf16 v[80:95], v[120:123], v[104:107], 0
    s_add_u32 s5, s5, 8192
    v_exp_f32 v69, v69
    v_exp_f32 v70, v70
    v_exp_f32 v71, v71
    v_exp_f32 v72, v72
    v_exp_f32 v73, v73
    v_smfmac_f32_32x32x32_bf16 v[16:31], v[140:143], v[64:71], v236
    s_waitcnt lgkmcnt(0)
    s_add_u32 m0, s19, 2048
    v_exp_f32 v74, v74
    v_exp_f32 v75, v75
    v_exp_f32 v76, v76
    v_exp_f32 v77, v77
    v_mfma_f32_32x32x16_bf16 v[196:211], v[228:231], v[164:167], v[196:211]
    ds_read_b64_tr_b16 v[232:233], v248 offset:2048
    ds_read_b64_tr_b16 v[234:235], v248 offset:3072
    v_exp_f32 v78, v78
    v_exp_f32 v79, v79
    v_exp_f32 v80, v80
    v_exp_f32 v81, v81
    v_smfmac_f32_32x32x32_bf16 v[16:31], v[144:147], v[72:79], v236
    v_exp_f32 v82, v82
    v_exp_f32 v83, v83
    v_exp_f32 v84, v84
    v_mfma_f32_32x32x16_bf16 v[64:79], v[120:123], v[108:111], 0
    s_add_u32 s18, s18, 16384
    v_exp_f32 v85, v85
    v_exp_f32 v86, v86
    v_exp_f32 v87, v87
    v_exp_f32 v88, v88
    v_exp_f32 v89, v89
    v_smfmac_f32_32x32x32_bf16 v[32:47], v[140:143], v[80:87], v236
    s_waitcnt lgkmcnt(0)
    buffer_load_dwordx4 v239, s[44:47], s18 offen lds
    buffer_load_dwordx4 v247, s[44:47], s18 offen offset:1024 lds
    buffer_load_dwordx4 v[160:163], v237, s[52:55], s6 offen offset:3072 sc1
    v_exp_f32 v90, v90
    v_exp_f32 v91, v91
    v_exp_f32 v92, v92
    v_exp_f32 v93, v93
    v_mfma_f32_32x32x16_bf16 v[212:227], v[232:235], v[164:167], v[212:227]
    s_waitcnt vmcnt(10)
    ds_read_b64_tr_b16 v[228:229], v243 offset:4096
    ds_read_b64_tr_b16 v[230:231], v243 offset:5120
    v_exp_f32 v94, v94
    v_exp_f32 v95, v95
    v_exp_f32 v64, v64
    v_exp_f32 v65, v65
    v_smfmac_f32_32x32x32_bf16 v[32:47], v[144:147], v[88:95], v236
    v_exp_f32 v66, v66
    v_exp_f32 v67, v67
    v_exp_f32 v68, v68
    v_mfma_f32_32x32x16_bf16 v[80:95], v[120:123], v[96:99], 0
    v_exp_f32 v69, v69
    v_exp_f32 v70, v70
    v_exp_f32 v71, v71
    v_exp_f32 v72, v72
    v_exp_f32 v73, v73
    v_smfmac_f32_32x32x32_bf16 v[48:63], v[140:143], v[64:71], v236
    s_waitcnt lgkmcnt(0)
    s_add_u32 m0, s19, 4096
    v_exp_f32 v74, v74
    v_exp_f32 v75, v75
    v_exp_f32 v76, v76
    v_exp_f32 v77, v77
    v_mfma_f32_32x32x16_bf16 v[196:211], v[228:231], v[168:171], v[196:211]
    ds_read_b64_tr_b16 v[232:233], v248 offset:4096
    ds_read_b64_tr_b16 v[234:235], v248 offset:5120
    v_exp_f32 v78, v78
    v_exp_f32 v79, v79
    v_exp_f32 v80, v80
    v_exp_f32 v81, v81
    v_smfmac_f32_32x32x32_bf16 v[48:63], v[144:147], v[72:79], v236
    s_add_u32 s6, s6, 4096
    v_exp_f32 v82, v82
    v_exp_f32 v83, v83
    v_exp_f32 v84, v84
    v_mfma_f32_32x32x16_bf16 v[64:79], v[112:115], v[100:103], 0
    s_add_u32 s18, s18, 16384
    v_exp_f32 v85, v85
    v_exp_f32 v86, v86
    v_exp_f32 v87, v87
    v_exp_f32 v88, v88
    v_exp_f32 v89, v89
    v_smfmac_f32_32x32x32_bf16 v[0:15], v[140:143], v[80:87], v236
    s_waitcnt lgkmcnt(0)
    buffer_load_dwordx4 v239, s[44:47], s18 offen lds
    buffer_load_dwordx4 v247, s[44:47], s18 offen offset:1024 lds
    buffer_load_dwordx4 v[164:167], v237, s[52:55], s6 offen offset:0 sc1
    v_exp_f32 v90, v90
    v_exp_f32 v91, v91
    v_exp_f32 v92, v92
    v_exp_f32 v93, v93
    v_mfma_f32_32x32x16_bf16 v[212:227], v[232:235], v[168:171], v[212:227]
    s_waitcnt vmcnt(10)
    ds_read_b64_tr_b16 v[228:229], v243 offset:0
    ds_read_b64_tr_b16 v[230:231], v243 offset:1024
    v_exp_f32 v94, v94
    v_exp_f32 v95, v95
    v_exp_f32 v64, v64
    v_exp_f32 v65, v65
    v_smfmac_f32_32x32x32_bf16 v[0:15], v[144:147], v[88:95], v236
    buffer_load_dwordx4 v[120:123], v237, s[52:55], s5 offen sc1
    s_mov_b64 exec, s[26:27]
    buffer_load_dwordx4 v[140:143], v238, s[52:55], s5 offen offset:1024 sc1
    buffer_load_dwordx4 v[144:147], v238, s[52:55], s5 offen offset:1536 sc1
    s_mov_b64 exec, -1
    v_exp_f32 v66, v66
    v_exp_f32 v67, v67
    v_exp_f32 v68, v68
    v_mfma_f32_32x32x16_bf16 v[80:95], v[112:115], v[104:107], 0
    s_add_u32 s5, s5, 8192
    v_exp_f32 v69, v69
    v_exp_f32 v70, v70
    v_exp_f32 v71, v71
    v_exp_f32 v72, v72
    v_exp_f32 v73, v73
    v_smfmac_f32_32x32x32_bf16 v[16:31], v[124:127], v[64:71], v236
    s_waitcnt lgkmcnt(0)
    s_add_u32 m0, s19, 0
    v_exp_f32 v74, v74
    v_exp_f32 v75, v75
    v_exp_f32 v76, v76
    v_exp_f32 v77, v77
    v_mfma_f32_32x32x16_bf16 v[196:211], v[228:231], v[172:175], v[196:211]
    ds_read_b64_tr_b16 v[232:233], v248 offset:0
    ds_read_b64_tr_b16 v[234:235], v248 offset:1024
    v_exp_f32 v78, v78
    v_exp_f32 v79, v79
    v_exp_f32 v80, v80
    v_exp_f32 v81, v81
    v_smfmac_f32_32x32x32_bf16 v[16:31], v[128:131], v[72:79], v236
    v_exp_f32 v82, v82
    v_exp_f32 v83, v83
    v_exp_f32 v84, v84
    v_mfma_f32_32x32x16_bf16 v[64:79], v[112:115], v[108:111], 0
    s_add_u32 s18, s18, 16384
    v_exp_f32 v85, v85
    v_exp_f32 v86, v86
    v_exp_f32 v87, v87
    v_exp_f32 v88, v88
    v_exp_f32 v89, v89
    v_smfmac_f32_32x32x32_bf16 v[32:47], v[124:127], v[80:87], v236
    s_waitcnt lgkmcnt(0)
    buffer_load_dwordx4 v239, s[44:47], s18 offen lds
    buffer_load_dwordx4 v247, s[44:47], s18 offen offset:1024 lds
    buffer_load_dwordx4 v[168:171], v237, s[52:55], s6 offen offset:1024 sc1
    v_exp_f32 v90, v90
    v_exp_f32 v91, v91
    v_exp_f32 v92, v92
    v_exp_f32 v93, v93
    v_mfma_f32_32x32x16_bf16 v[212:227], v[232:235], v[172:175], v[212:227]
    s_waitcnt vmcnt(10)
    ds_read_b64_tr_b16 v[228:229], v243 offset:2048
    ds_read_b64_tr_b16 v[230:231], v243 offset:3072
    v_exp_f32 v94, v94
    v_exp_f32 v95, v95
    v_exp_f32 v64, v64
    v_exp_f32 v65, v65
    v_smfmac_f32_32x32x32_bf16 v[32:47], v[128:131], v[88:95], v236
    v_exp_f32 v66, v66
    v_exp_f32 v67, v67
    v_exp_f32 v68, v68
    v_mfma_f32_32x32x16_bf16 v[80:95], v[112:115], v[96:99], 0
    s_lshr_b32 s73, s70, 2
    s_lshl_b32 s73, s73, 1
    s_and_b32 s74, s71, 1
    s_add_u32 s73, s73, s74
    s_lshl_b32 s73, s73, 3
    s_add_u32 s73, s73, s68
    s_and_b32 s74, s15, 0x3ff
    v_lshlrev_b32 v240, 10, v252
    s_lshl_b32 s73, s73, 13
    s_add_u32 s73, s73, s74
    s_mov_b64 exec, 0xff
    buffer_load_dword v251, v240, s[36:39], s73 offen
    s_mov_b64 exec, -1
    v_exp_f32 v69, v69
    v_exp_f32 v70, v70
    v_exp_f32 v71, v71
    v_exp_f32 v72, v72
    v_exp_f32 v73, v73
    v_smfmac_f32_32x32x32_bf16 v[48:63], v[124:127], v[64:71], v236
    s_waitcnt lgkmcnt(0)
    v_exp_f32 v74, v74
    v_exp_f32 v75, v75
    v_exp_f32 v76, v76
    v_exp_f32 v77, v77
    v_mfma_f32_32x32x16_bf16 v[196:211], v[228:231], v[176:179], v[196:211]
    ds_read_b64_tr_b16 v[232:233], v248 offset:2048
    ds_read_b64_tr_b16 v[234:235], v248 offset:3072
    v_exp_f32 v78, v78
    v_exp_f32 v79, v79
    v_exp_f32 v80, v80
    v_exp_f32 v81, v81
    v_smfmac_f32_32x32x32_bf16 v[48:63], v[128:131], v[72:79], v236
    v_exp_f32 v82, v82
    v_exp_f32 v83, v83
    v_exp_f32 v84, v84
    v_mfma_f32_32x32x16_bf16 v[64:79], v[116:119], v[100:103], 0
    v_exp_f32 v85, v85
    v_exp_f32 v86, v86
    v_exp_f32 v87, v87
    v_exp_f32 v88, v88
    v_exp_f32 v89, v89
    v_smfmac_f32_32x32x32_bf16 v[0:15], v[124:127], v[80:87], v236
    s_waitcnt lgkmcnt(0)
    buffer_load_dwordx4 v[172:175], v237, s[52:55], s6 offen offset:2048 sc1
    v_exp_f32 v90, v90
    v_exp_f32 v91, v91
    v_exp_f32 v92, v92
    v_exp_f32 v93, v93
    v_mfma_f32_32x32x16_bf16 v[212:227], v[232:235], v[176:179], v[212:227]
    s_waitcnt vmcnt(9)
    ds_read_b64_tr_b16 v[228:229], v243 offset:4096
    ds_read_b64_tr_b16 v[230:231], v243 offset:5120
    v_exp_f32 v94, v94
    v_exp_f32 v95, v95
    v_exp_f32 v64, v64
    v_exp_f32 v65, v65
    v_smfmac_f32_32x32x32_bf16 v[0:15], v[128:131], v[88:95], v236
    v_exp_f32 v66, v66
    v_exp_f32 v67, v67
    v_exp_f32 v68, v68
    v_mfma_f32_32x32x16_bf16 v[80:95], v[116:119], v[104:107], 0
    v_exp_f32 v69, v69
    v_exp_f32 v70, v70
    v_exp_f32 v71, v71
    v_exp_f32 v72, v72
    v_exp_f32 v73, v73
    v_smfmac_f32_32x32x32_bf16 v[16:31], v[132:135], v[64:71], v236
    s_waitcnt lgkmcnt(0)
    v_exp_f32 v74, v74
    v_exp_f32 v75, v75
    v_exp_f32 v76, v76
    v_exp_f32 v77, v77
    v_mfma_f32_32x32x16_bf16 v[196:211], v[228:231], v[180:183], v[196:211]
    ds_read_b64_tr_b16 v[232:233], v248 offset:4096
    ds_read_b64_tr_b16 v[234:235], v248 offset:5120
    v_exp_f32 v78, v78
    v_exp_f32 v79, v79
    v_exp_f32 v80, v80
    v_exp_f32 v81, v81
    v_smfmac_f32_32x32x32_bf16 v[16:31], v[136:139], v[72:79], v236
    s_add_u32 s22, s15, 0x8000
    s_and_b32 s23, s15, 0x3ff
    v_exp_f32 v82, v82
    v_exp_f32 v83, v83
    v_exp_f32 v84, v84
    v_mfma_f32_32x32x16_bf16 v[64:79], v[116:119], v[108:111], 0
    v_exp_f32 v85, v85
    v_exp_f32 v86, v86
    v_exp_f32 v87, v87
    v_exp_f32 v88, v88
    v_exp_f32 v89, v89
    v_smfmac_f32_32x32x32_bf16 v[32:47], v[132:135], v[80:87], v236
    s_waitcnt lgkmcnt(0)
    buffer_load_dwordx4 v[176:179], v237, s[52:55], s6 offen offset:3072 sc1
    v_exp_f32 v90, v90
    v_exp_f32 v91, v91
    v_exp_f32 v92, v92
    v_exp_f32 v93, v93
    v_mfma_f32_32x32x16_bf16 v[212:227], v[232:235], v[180:183], v[212:227]
    s_waitcnt vmcnt(4)
    ds_read_b64_tr_b16 v[228:229], v243 offset:0
    ds_read_b64_tr_b16 v[230:231], v243 offset:1024
    v_exp_f32 v94, v94
    v_exp_f32 v95, v95
    v_exp_f32 v64, v64
    v_exp_f32 v65, v65
    v_smfmac_f32_32x32x32_bf16 v[32:47], v[136:139], v[88:95], v236
    v_and_b32 v240, 0x70, v237
    v_lshrrev_b32 v245, 3, v252
    v_lshl_add_u32 v245, v245, 10, v240
    v_exp_f32 v66, v66
    v_exp_f32 v67, v67
    v_exp_f32 v68, v68
    v_mfma_f32_32x32x16_bf16 v[80:95], v[116:119], v[96:99], 0
    v_exp_f32 v69, v69
    v_exp_f32 v70, v70
    v_exp_f32 v71, v71
    v_exp_f32 v72, v72
    v_exp_f32 v73, v73
    v_smfmac_f32_32x32x32_bf16 v[48:63], v[132:135], v[64:71], v236
    s_waitcnt lgkmcnt(0)
    v_exp_f32 v74, v74
    v_exp_f32 v75, v75
    v_exp_f32 v76, v76
    v_exp_f32 v77, v77
    v_mfma_f32_32x32x16_bf16 v[196:211], v[228:231], v[184:187], v[196:211]
    ds_read_b64_tr_b16 v[232:233], v248 offset:0
    ds_read_b64_tr_b16 v[234:235], v248 offset:1024
    v_exp_f32 v78, v78
    v_exp_f32 v79, v79
    v_exp_f32 v80, v80
    v_exp_f32 v81, v81
    v_smfmac_f32_32x32x32_bf16 v[48:63], v[136:139], v[72:79], v236
    s_add_u32 s6, s6, 4096
    s_min_u32 s6, s6, s13
    v_exp_f32 v82, v82
    v_exp_f32 v83, v83
    v_exp_f32 v84, v84
    v_mfma_f32_32x32x16_bf16 v[64:79], v[120:123], v[100:103], 0
    v_exp_f32 v85, v85
    v_exp_f32 v86, v86
    v_exp_f32 v87, v87
    v_exp_f32 v88, v88
    v_exp_f32 v89, v89
    v_smfmac_f32_32x32x32_bf16 v[0:15], v[132:135], v[80:87], v236
    s_waitcnt lgkmcnt(0)
    buffer_load_dwordx4 v[180:183], v237, s[52:55], s6 offen offset:0 sc1
    v_exp_f32 v90, v90
    v_exp_f32 v91, v91
    v_exp_f32 v92, v92
    v_exp_f32 v93, v93
    v_mfma_f32_32x32x16_bf16 v[212:227], v[232:235], v[184:187], v[212:227]
    v_exp_f32 v94, v94
    v_exp_f32 v95, v95
    v_exp_f32 v64, v64
    v_exp_f32 v65, v65
    v_smfmac_f32_32x32x32_bf16 v[0:15], v[136:139], v[88:95], v236
    buffer_load_dwordx4 v[132:135], v245, s[28:31], s15 offen
    buffer_load_dwordx4 v[136:139], v245, s[28:31], s22 offen
    buffer_load_dwordx4 v[116:119], v240, s[60:63], s23 offen
    s_and_b32 s73, s12, 0xfffff800
    v_add_u32 v243, s73, v241
    v_add_u32 v248, s73, v242
    v_exp_f32 v66, v66
    v_exp_f32 v67, v67
    v_exp_f32 v68, v68
    v_mfma_f32_32x32x16_bf16 v[80:95], v[120:123], v[104:107], 0
    s_setprio 0
    v_add_u32 v124, s19, v237
    v_exp_f32 v69, v69
    v_exp_f32 v70, v70
    v_exp_f32 v71, v71
    v_exp_f32 v72, v72
    v_exp_f32 v73, v73
    v_exp_f32 v74, v74
    v_smfmac_f32_32x32x32_bf16 v[16:31], v[140:143], v[64:71], v236
    s_xor_b32 s73, s68, 1
    s_mul_i32 s73, s73, 7168
    v_exp_f32 v75, v75
    v_exp_f32 v76, v76
    v_exp_f32 v77, v77
    v_exp_f32 v78, v78
    v_exp_f32 v79, v79
    v_exp_f32 v80, v80
    v_exp_f32 v81, v81
    v_smfmac_f32_32x32x32_bf16 v[16:31], v[144:147], v[72:79], v236
    s_add_u32 s73, s73, 98304
    v_add_u32 v125, s73, v237
    v_exp_f32 v82, v82
    v_exp_f32 v83, v83
    v_exp_f32 v84, v84
    v_mfma_f32_32x32x16_bf16 v[64:79], v[120:123], v[108:111], 0
    v_exp_f32 v85, v85
    v_exp_f32 v86, v86
    v_exp_f32 v87, v87
    v_exp_f32 v88, v88
    v_exp_f32 v89, v89
    v_exp_f32 v90, v90
    v_smfmac_f32_32x32x32_bf16 v[32:47], v[140:143], v[80:87], v236
    buffer_load_dwordx4 v[184:187], v237, s[52:55], s6 offen offset:1024 sc1
    s_xor_b32 s73, s68, 2
    s_mul_i32 s73, s73, 7168
    v_exp_f32 v91, v91
    v_exp_f32 v92, v92
    v_exp_f32 v93, v93
    v_exp_f32 v94, v94
    v_exp_f32 v95, v95
    v_exp_f32 v64, v64
    v_exp_f32 v65, v65
    v_smfmac_f32_32x32x32_bf16 v[32:47], v[144:147], v[88:95], v236
    ds_write_b128 v124, v[16:19] offset:0
    ds_write_b128 v124, v[20:23] offset:1024
    ds_write_b32 v124, v24 offset:6148
    v_exp_f32 v66, v66
    v_exp_f32 v67, v67
    v_exp_f32 v68, v68
    v_mfma_f32_32x32x16_bf16 v[80:95], v[120:123], v[96:99], 0
    s_add_u32 s73, s73, 98304
    v_add_u32 v126, s73, v237
    v_exp_f32 v69, v69
    v_exp_f32 v70, v70
    v_exp_f32 v71, v71
    v_exp_f32 v72, v72
    v_exp_f32 v73, v73
    v_exp_f32 v74, v74
    v_smfmac_f32_32x32x32_bf16 v[48:63], v[140:143], v[64:71], v236
    s_xor_b32 s73, s68, 3
    s_mul_i32 s73, s73, 7168
    v_exp_f32 v75, v75
    v_exp_f32 v76, v76
    v_exp_f32 v77, v77
    v_exp_f32 v78, v78
    v_exp_f32 v79, v79
    v_exp_f32 v80, v80
    v_exp_f32 v81, v81
    v_smfmac_f32_32x32x32_bf16 v[48:63], v[144:147], v[72:79], v236
    ds_write_b128 v124, v[32:35] offset:2048
    ds_write_b128 v124, v[36:39] offset:3072
    ds_write_b32 v124, v40 offset:6152
    v_exp_f32 v82, v82
    v_exp_f32 v83, v83
    v_exp_f32 v84, v84
    s_add_u32 s73, s73, 98304
    v_add_u32 v127, s73, v237
    v_exp_f32 v85, v85
    v_exp_f32 v86, v86
    v_exp_f32 v87, v87
    v_exp_f32 v88, v88
    v_exp_f32 v89, v89
    v_exp_f32 v90, v90
    v_smfmac_f32_32x32x32_bf16 v[0:15], v[140:143], v[80:87], v236
    ds_write_b128 v124, v[48:51] offset:4096
    ds_write_b128 v124, v[52:55] offset:5120
    ds_write_b32 v124, v56 offset:6156
    v_exp_f32 v91, v91
    v_exp_f32 v92, v92
    v_exp_f32 v93, v93
    v_exp_f32 v94, v94
    v_exp_f32 v95, v95
    s_waitcnt lgkmcnt(0)
    s_nop 0
    v_smfmac_f32_32x32x32_bf16 v[0:15], v[144:147], v[88:95], v236
L_TAIL:
    s_barrier
    ds_read_b32 v24, v125 offset:6148
    ds_read_b32 v40, v126 offset:6152
    ds_read_b32 v56, v127 offset:6156
    ds_read_b128 v[16:19], v125 offset:0
    ds_read_b128 v[20:23], v125 offset:1024
    ds_read_b128 v[32:35], v126 offset:2048
    ds_read_b128 v[36:39], v126 offset:3072
    ds_read_b128 v[48:51], v127 offset:4096
    ds_read_b128 v[52:55], v127 offset:5120
    s_waitcnt lgkmcnt(6)
    v_add_f32 v24, v24, v40
    v_add_f32 v8, v8, v56
    v_add_f32 v8, v8, v24
    v_rcp_f32 v66, v8
    v_cmp_nle_f32 vcc, 0x2b800000, v8
    s_waitcnt lgkmcnt(4)
    s_mov_b64 s[76:77], vcc
    v_cmp_nge_f32 vcc, 0x5f800000, v8
    v_pk_add_f32 v[0:1], v[0:1], v[16:17]
    v_pk_add_f32 v[2:3], v[2:3], v[18:19]
    v_pk_add_f32 v[4:5], v[4:5], v[20:21]
    v_pk_add_f32 v[6:7], v[6:7], v[22:23]
    s_waitcnt lgkmcnt(2)
    s_or_b64 s[76:77], s[76:77], vcc
    v_pk_add_f32 v[0:1], v[0:1], v[32:33]
    v_pk_add_f32 v[2:3], v[2:3], v[34:35]
    v_pk_add_f32 v[4:5], v[4:5], v[36:37]
    v_pk_add_f32 v[6:7], v[6:7], v[38:39]
    s_waitcnt lgkmcnt(0)
    v_pk_add_f32 v[0:1], v[0:1], v[48:49]
    v_pk_add_f32 v[2:3], v[2:3], v[50:51]
    v_pk_add_f32 v[4:5], v[4:5], v[52:53]
    v_pk_add_f32 v[6:7], v[6:7], v[54:55]
    v_pk_mul_f32 v[0:1], v[0:1], v[66:67] op_sel_hi:[1,0]
    v_pk_mul_f32 v[2:3], v[2:3], v[66:67] op_sel_hi:[1,0]
    v_pk_mul_f32 v[4:5], v[4:5], v[66:67] op_sel_hi:[1,0]
    v_pk_mul_f32 v[6:7], v[6:7], v[66:67] op_sel_hi:[1,0]
    v_cvt_pk_bf16_f32 v68, v0, v1
    v_cvt_pk_bf16_f32 v69, v2, v3
    v_cvt_pk_bf16_f32 v70, v4, v5
    v_cvt_pk_bf16_f32 v71, v6, v7
    buffer_store_dwordx4 v[68:71], v237, s[52:55], s14 offen sc1
    ds_read_b64_tr_b16 v[32:33], v243 offset:0
    ds_read_b64_tr_b16 v[34:35], v243 offset:1024
    ds_read_b64_tr_b16 v[36:37], v248 offset:0
    ds_read_b64_tr_b16 v[38:39], v248 offset:1024
    ds_read_b64_tr_b16 v[40:41], v243 offset:8192
    ds_read_b64_tr_b16 v[42:43], v243 offset:9216
    ds_read_b64_tr_b16 v[44:45], v248 offset:8192
    ds_read_b64_tr_b16 v[46:47], v248 offset:9216
    v_add_f32 v66, |v0|, |v1|
    v_add_f32 v67, |v2|, |v3|
    v_add_f32 v66, |v4|, v66
    v_add_f32 v67, |v5|, v67
    v_add_f32 v66, |v6|, v66
    v_add_f32 v67, |v7|, v67
    v_add_f32 v66, v66, v67
    v_cmp_nge_f32 vcc, 0x7e800000, v66
    s_nop 0
    s_or_b64 s[76:77], s[76:77], vcc
    s_cbranch_scc1 L_SLOW
L_NORM:
    s_lshl_b32 s76, s68, 13
    s_and_b32 s74, s15, 0x3ff
    s_add_u32 s76, s76, s74
    s_sub_u32 s76, s76, 0x10000
    s_cmp_ge_u32 s68, 4
    s_barrier
    s_cbranch_scc1 L_TC
    s_waitcnt lgkmcnt(4)
    v_mfma_f32_32x32x16_bf16 v[196:211], v[32:35], v[188:191], v[196:211]
    ds_read_b64_tr_b16 v[48:49], v243 offset:16384
    ds_read_b64_tr_b16 v[50:51], v243 offset:17408
    ds_read_b64_tr_b16 v[52:53], v248 offset:16384
    ds_read_b64_tr_b16 v[54:55], v248 offset:17408
    v_mfma_f32_32x32x16_bf16 v[212:227], v[36:39], v[188:191], v[212:227]
    s_add_u32 m0, s12, 98304
    s_add_u32 s76, s76, 0x10000
    buffer_load_dwordx4 v239, s[36:39], s76 offen lds
    v_and_b32 v240, 7, v252
    v_xor_b32 v74, v240, v253
    v_lshlrev_b32 v74, 4, v74
    v_lshl_add_u32 v74, v254, 8, v74
    s_lshl_b32 s74, s68, 13
    s_waitcnt lgkmcnt(4)
    v_mfma_f32_32x32x16_bf16 v[196:211], v[40:43], v[192:195], v[196:211]
    ds_read_b64_tr_b16 v[56:57], v243 offset:24576
    ds_read_b64_tr_b16 v[58:59], v243 offset:25600
    ds_read_b64_tr_b16 v[60:61], v248 offset:24576
    ds_read_b64_tr_b16 v[62:63], v248 offset:25600
    v_mfma_f32_32x32x16_bf16 v[212:227], v[44:47], v[192:195], v[212:227]
    s_add_u32 m0, s12, 106496
    s_add_u32 s76, s76, 0x10000
    buffer_load_dwordx4 v239, s[36:39], s76 offen lds
    v_add_u32 v74, s74, v74
    v_xor_b32 v75, 32, v74
    v_xor_b32 v76, 64, v74
    v_xor_b32 v77, 0x60, v74
    s_lshr_b32 s73, s68, 1
    s_waitcnt lgkmcnt(4)
    v_mfma_f32_32x32x16_bf16 v[196:211], v[48:51], v[148:151], v[196:211]
    ds_read_b64_tr_b16 v[32:33], v243 offset:32768
    ds_read_b64_tr_b16 v[34:35], v243 offset:33792
    ds_read_b64_tr_b16 v[36:37], v248 offset:32768
    ds_read_b64_tr_b16 v[38:39], v248 offset:33792
    v_mfma_f32_32x32x16_bf16 v[212:227], v[52:55], v[148:151], v[212:227]
    s_add_u32 m0, s12, 114688
    s_add_u32 s76, s76, 0x10000
    buffer_load_dwordx4 v239, s[36:39], s76 offen lds
    s_lshl_b32 s74, s73, 2
    s_add_u32 s78, s3, s74
    s_lshr_b32 s74, s71, 3
    s_xor_b32 s74, s74, s73
    s_add_u32 s20, s74, 7
    s_waitcnt lgkmcnt(4)
    v_mfma_f32_32x32x16_bf16 v[196:211], v[56:59], v[152:155], v[196:211]
    ds_read_b64_tr_b16 v[40:41], v243 offset:40960
    ds_read_b64_tr_b16 v[42:43], v243 offset:41984
    ds_read_b64_tr_b16 v[44:45], v248 offset:40960
    ds_read_b64_tr_b16 v[46:47], v248 offset:41984
    v_mfma_f32_32x32x16_bf16 v[212:227], v[60:63], v[152:155], v[212:227]
    s_add_u32 m0, s12, 122880
    s_add_u32 s76, s76, 0x10000
    buffer_load_dwordx4 v239, s[36:39], s76 offen lds
    s_lshr_b32 s75, s15, 16
    s_lshl_b32 s75, s75, 1
    s_and_b32 s74, s68, 1
    s_add_u32 s75, s75, s74
    s_lshl_b32 s75, s75, 1
    s_waitcnt lgkmcnt(4)
    v_mfma_f32_32x32x16_bf16 v[196:211], v[32:35], v[156:159], v[196:211]
    ds_read_b64_tr_b16 v[48:49], v243 offset:49152
    ds_read_b64_tr_b16 v[50:51], v243 offset:50176
    ds_read_b64_tr_b16 v[52:53], v248 offset:49152
    ds_read_b64_tr_b16 v[54:55], v248 offset:50176
    v_mfma_f32_32x32x16_bf16 v[212:227], v[36:39], v[156:159], v[212:227]
    s_add_u32 m0, s12, 131072
    s_add_u32 s76, s76, 0x10000
    buffer_load_dwordx4 v239, s[36:39], s76 offen lds
    s_add_u32 s75, s75, s73
    s_lshl_b32 s75, s75, 14
    s_add_u32 s75, s75, 9830400
    s_waitcnt vmcnt(5)
    s_barrier
    s_waitcnt lgkmcnt(4)
    v_mfma_f32_32x32x16_bf16 v[196:211], v[40:43], v[160:163], v[196:211]
    ds_read_b64_tr_b16 v[56:57], v243 offset:57344
    ds_read_b64_tr_b16 v[58:59], v243 offset:58368
    ds_read_b64_tr_b16 v[60:61], v248 offset:57344
    ds_read_b64_tr_b16 v[62:63], v248 offset:58368
    s_add_u32 m0, s12, 139264
    s_add_u32 s76, s76, 0x10000
    buffer_load_dwordx4 v239, s[36:39], s76 offen lds
    v_mfma_f32_32x32x16_bf16 v[212:227], v[44:47], v[160:163], v[212:227]
    s_add_u32 m0, s12, 147456
    s_add_u32 s76, s76, 0x10000
    buffer_load_dwordx4 v239, s[36:39], s76 offen lds
    s_mov_b64 exec, 1
    v_mov_b32 v244, 0
    buffer_atomic_umax v244, off, s[52:55], s78 offset:32 sc0 sc1
    s_mov_b64 exec, -1
    s_waitcnt lgkmcnt(4)
    v_mfma_f32_32x32x16_bf16 v[196:211], v[48:51], v[164:167], v[196:211]
    v_add_u32 v243, 65536, v243
    ds_read_b64_tr_b16 v[32:33], v243 offset:0
    ds_read_b64_tr_b16 v[34:35], v243 offset:1024
    v_add_u32 v248, 65536, v248
    ds_read_b64_tr_b16 v[36:37], v248 offset:0
    ds_read_b64_tr_b16 v[38:39], v248 offset:1024
    s_add_u32 m0, s12, 155648
    s_add_u32 s76, s76, 0x10000
    buffer_load_dwordx4 v239, s[36:39], s76 offen lds
    v_mfma_f32_32x32x16_bf16 v[212:227], v[52:55], v[164:167], v[212:227]
    s_waitcnt lgkmcnt(4)
    v_mfma_f32_32x32x16_bf16 v[196:211], v[56:59], v[168:171], v[196:211]
    ds_read_b64_tr_b16 v[40:41], v243 offset:8192
    ds_read_b64_tr_b16 v[42:43], v243 offset:9216
    ds_read_b64_tr_b16 v[44:45], v248 offset:8192
    ds_read_b64_tr_b16 v[46:47], v248 offset:9216
    v_mfma_f32_32x32x16_bf16 v[212:227], v[60:63], v[168:171], v[212:227]
    s_barrier
    s_mov_b64 exec, 1
    v_mov_b32 v245, 0
    buffer_atomic_umax v245, off, s[52:55], s78 offset:32 sc0 sc1
    s_mov_b64 exec, -1
    s_waitcnt lgkmcnt(4)
    v_mfma_f32_32x32x16_bf16 v[196:211], v[32:35], v[172:175], v[196:211]
    ds_read_b64_tr_b16 v[48:49], v243 offset:16384
    ds_read_b64_tr_b16 v[50:51], v243 offset:17408
    ds_read_b64_tr_b16 v[52:53], v248 offset:16384
    ds_read_b64_tr_b16 v[54:55], v248 offset:17408
    v_mfma_f32_32x32x16_bf16 v[212:227], v[36:39], v[172:175], v[212:227]
    s_waitcnt lgkmcnt(4)
    v_mfma_f32_32x32x16_bf16 v[196:211], v[40:43], v[176:179], v[196:211]
    ds_read_b64_tr_b16 v[56:57], v243 offset:24576
    ds_read_b64_tr_b16 v[58:59], v243 offset:25600
    ds_read_b64_tr_b16 v[60:61], v248 offset:24576
    ds_read_b64_tr_b16 v[62:63], v248 offset:25600
    v_mfma_f32_32x32x16_bf16 v[212:227], v[44:47], v[176:179], v[212:227]
    s_mov_b64 exec, 1
    v_mov_b32 v246, 0
    buffer_atomic_umax v246, off, s[52:55], s78 offset:32 sc0 sc1
    s_mov_b64 exec, -1
    s_waitcnt lgkmcnt(4)
    v_mfma_f32_32x32x16_bf16 v[196:211], v[48:51], v[180:183], v[196:211]
    v_mfma_f32_32x32x16_bf16 v[212:227], v[52:55], v[180:183], v[212:227]
    s_waitcnt vmcnt(2)
    s_mov_b64 exec, 1
    s_mov_b32 s79, 262144
L_f3:
    s_waitcnt vmcnt(2)
    v_cmp_gt_u32 vcc, s20, v244
    s_nop 1
    s_cmp_eq_u64 vcc, 0
    s_cbranch_scc1 L_f3d
    buffer_atomic_umax v244, off, s[52:55], s78 offset:32 sc0 sc1
    s_waitcnt vmcnt(2)
    v_cmp_gt_u32 vcc, s20, v245
    s_nop 1
    s_cmp_eq_u64 vcc, 0
    s_cbranch_scc1 L_f3d
    buffer_atomic_umax v245, off, s[52:55], s78 offset:32 sc0 sc1
    s_waitcnt vmcnt(2)
    v_cmp_gt_u32 vcc, s20, v246
    s_nop 1
    s_cmp_eq_u64 vcc, 0
    s_cbranch_scc1 L_f3d
    buffer_atomic_umax v246, off, s[52:55], s78 offset:32 sc0 sc1
    s_sub_u32 s79, s79, 1
    s_cmp_lg_u32 s79, 0
    s_cbranch_scc1 L_f3
L_f3d:
    s_mov_b64 exec, -1
    buffer_load_dwordx4 v[96:99], v237, s[52:55], s75 offen offset:0 sc1
    buffer_load_dwordx4 v[100:103], v237, s[52:55], s75 offen offset:1024 sc1
    s_waitcnt lgkmcnt(0)
    v_mfma_f32_32x32x16_bf16 v[196:211], v[56:59], v[184:187], v[196:211]
    buffer_load_dwordx4 v[104:107], v237, s[52:55], s75 offen offset:2048 sc1
    v_mfma_f32_32x32x16_bf16 v[212:227], v[60:63], v[184:187], v[212:227]
    buffer_load_dwordx4 v[108:111], v237, s[52:55], s75 offen offset:3072 sc1
L_pad5:
    s_cbranch_execz L_wret
    s_add_u32 s75, s75, 4096
    s_lshl_b32 s74, s73, 15
    s_add_u32 s74, s74, 98304
    v_add_u32 v243, s74, v241
    v_add_u32 v248, s74, v242
    buffer_load_dwordx4 v[112:115], v237, s[52:55], s75 offen offset:0 sc1
    buffer_load_dwordx4 v[116:119], v237, s[52:55], s75 offen offset:1024 sc1
    buffer_load_dwordx4 v[120:123], v237, s[52:55], s75 offen offset:2048 sc1
    buffer_load_dwordx4 v[124:127], v237, s[52:55], s75 offen offset:3072 sc1
    s_add_u32 s75, s75, 4096
    ds_write_b128 v74, v[196:199] offset:0
    buffer_load_dwordx4 v[128:131], v237, s[52:55], s75 offen offset:0 sc1
    ds_write_b128 v75, v[200:203] offset:0
    buffer_load_dwordx4 v[132:135], v237, s[52:55], s75 offen offset:1024 sc1
    ds_write_b128 v76, v[204:207] offset:0
    buffer_load_dwordx4 v[136:139], v237, s[52:55], s75 offen offset:2048 sc1
    ds_write_b128 v77, v[208:211] offset:0
    buffer_load_dwordx4 v[140:143], v237, s[52:55], s75 offen offset:3072 sc1
    s_add_u32 s75, s75, 4096
    ds_write_b128 v74, v[212:215] offset:128
    buffer_load_dwordx4 v[144:147], v237, s[52:55], s75 offen offset:0 sc1
    ds_write_b128 v75, v[216:219] offset:128
    buffer_load_dwordx4 v[0:3], v237, s[52:55], s75 offen offset:1024 sc1
    ds_write_b128 v76, v[220:223] offset:128
    buffer_load_dwordx4 v[4:7], v237, s[52:55], s75 offen offset:2048 sc1
    ds_write_b128 v77, v[224:227] offset:128
    buffer_load_dwordx4 v[8:11], v237, s[52:55], s75 offen offset:3072 sc1
    s_waitcnt lgkmcnt(0)
    s_barrier
    ds_read_b64_tr_b16 v[32:33], v243 offset:0
    ds_read_b64_tr_b16 v[34:35], v243 offset:1024
    ds_read_b64_tr_b16 v[36:37], v248 offset:0
    ds_read_b64_tr_b16 v[38:39], v248 offset:1024
    ds_read_b64_tr_b16 v[40:41], v243 offset:2048
    ds_read_b64_tr_b16 v[42:43], v243 offset:3072
    ds_read_b64_tr_b16 v[44:45], v248 offset:2048
    ds_read_b64_tr_b16 v[46:47], v248 offset:3072
    ds_read_b64_tr_b16 v[48:49], v243 offset:4096
    ds_read_b64_tr_b16 v[50:51], v243 offset:5120
    ds_read_b64_tr_b16 v[52:53], v248 offset:4096
    ds_read_b64_tr_b16 v[54:55], v248 offset:5120
    v_add_u32 v74, 65536, v74
    v_add_u32 v75, 65536, v75
    v_add_u32 v76, 65536, v76
    v_add_u32 v77, 65536, v77
    s_waitcnt vmcnt(15) lgkmcnt(8)
    v_mfma_f32_32x32x16_bf16 v[196:211], v[32:35], v[96:99], 0
    ds_read_b64_tr_b16 v[56:57], v243 offset:6144
    ds_read_b64_tr_b16 v[58:59], v243 offset:7168
    ds_read_b64_tr_b16 v[60:61], v248 offset:6144
    ds_read_b64_tr_b16 v[62:63], v248 offset:7168
    v_mfma_f32_32x32x16_bf16 v[212:227], v[36:39], v[96:99], 0
    s_waitcnt vmcnt(14) lgkmcnt(8)
    v_mfma_f32_32x32x16_bf16 v[196:211], v[40:43], v[100:103], v[196:211]
    ds_read_b64_tr_b16 v[32:33], v243 offset:8192
    ds_read_b64_tr_b16 v[34:35], v243 offset:9216
    ds_read_b64_tr_b16 v[36:37], v248 offset:8192
    ds_read_b64_tr_b16 v[38:39], v248 offset:9216
    v_mfma_f32_32x32x16_bf16 v[212:227], v[44:47], v[100:103], v[212:227]
    s_waitcnt vmcnt(13) lgkmcnt(8)
    v_mfma_f32_32x32x16_bf16 v[196:211], v[48:51], v[104:107], v[196:211]
    ds_read_b64_tr_b16 v[40:41], v243 offset:10240
    ds_read_b64_tr_b16 v[42:43], v243 offset:11264
    ds_read_b64_tr_b16 v[44:45], v248 offset:10240
    ds_read_b64_tr_b16 v[46:47], v248 offset:11264
    v_mfma_f32_32x32x16_bf16 v[212:227], v[52:55], v[104:107], v[212:227]
    s_waitcnt vmcnt(12) lgkmcnt(8)
    v_mfma_f32_32x32x16_bf16 v[196:211], v[56:59], v[108:111], v[196:211]
    ds_read_b64_tr_b16 v[48:49], v243 offset:12288
    ds_read_b64_tr_b16 v[50:51], v243 offset:13312
    ds_read_b64_tr_b16 v[52:53], v248 offset:12288
    ds_read_b64_tr_b16 v[54:55], v248 offset:13312
    v_mfma_f32_32x32x16_bf16 v[212:227], v[60:63], v[108:111], v[212:227]
    s_waitcnt vmcnt(11) lgkmcnt(8)
    v_mfma_f32_32x32x16_bf16 v[196:211], v[32:35], v[112:115], v[196:211]
    ds_read_b64_tr_b16 v[56:57], v243 offset:14336
    ds_read_b64_tr_b16 v[58:59], v243 offset:15360
    ds_read_b64_tr_b16 v[60:61], v248 offset:14336
    ds_read_b64_tr_b16 v[62:63], v248 offset:15360
    v_mfma_f32_32x32x16_bf16 v[212:227], v[36:39], v[112:115], v[212:227]
    s_waitcnt vmcnt(10) lgkmcnt(8)
    v_mfma_f32_32x32x16_bf16 v[196:211], v[40:43], v[116:119], v[196:211]
    ds_read_b64_tr_b16 v[32:33], v243 offset:16384
    ds_read_b64_tr_b16 v[34:35], v243 offset:17408
    ds_read_b64_tr_b16 v[36:37], v248 offset:16384
    ds_read_b64_tr_b16 v[38:39], v248 offset:17408
    v_mfma_f32_32x32x16_bf16 v[212:227], v[44:47], v[116:119], v[212:227]
    s_waitcnt vmcnt(9) lgkmcnt(8)
    v_mfma_f32_32x32x16_bf16 v[196:211], v[48:51], v[120:123], v[196:211]
    ds_read_b64_tr_b16 v[40:41], v243 offset:18432
    ds_read_b64_tr_b16 v[42:43], v243 offset:19456
    ds_read_b64_tr_b16 v[44:45], v248 offset:18432
    ds_read_b64_tr_b16 v[46:47], v248 offset:19456
    v_mfma_f32_32x32x16_bf16 v[212:227], v[52:55], v[120:123], v[212:227]
    s_waitcnt vmcnt(8) lgkmcnt(8)
    v_mfma_f32_32x32x16_bf16 v[196:211], v[56:59], v[124:127], v[196:211]
    ds_read_b64_tr_b16 v[48:49], v243 offset:20480
    ds_read_b64_tr_b16 v[50:51], v243 offset:21504
    ds_read_b64_tr_b16 v[52:53], v248 offset:20480
    ds_read_b64_tr_b16 v[54:55], v248 offset:21504
    v_mfma_f32_32x32x16_bf16 v[212:227], v[60:63], v[124:127], v[212:227]
    s_waitcnt vmcnt(7) lgkmcnt(8)
    v_mfma_f32_32x32x16_bf16 v[196:211], v[32:35], v[128:131], v[196:211]
    ds_read_b64_tr_b16 v[56:57], v243 offset:22528
    ds_read_b64_tr_b16 v[58:59], v243 offset:23552
    ds_read_b64_tr_b16 v[60:61], v248 offset:22528
    ds_read_b64_tr_b16 v[62:63], v248 offset:23552
    v_mfma_f32_32x32x16_bf16 v[212:227], v[36:39], v[128:131], v[212:227]
    s_waitcnt vmcnt(6) lgkmcnt(8)
    v_mfma_f32_32x32x16_bf16 v[196:211], v[40:43], v[132:135], v[196:211]
    ds_read_b64_tr_b16 v[32:33], v243 offset:24576
    ds_read_b64_tr_b16 v[34:35], v243 offset:25600
    ds_read_b64_tr_b16 v[36:37], v248 offset:24576
    ds_read_b64_tr_b16 v[38:39], v248 offset:25600
    v_mfma_f32_32x32x16_bf16 v[212:227], v[44:47], v[132:135], v[212:227]
    s_waitcnt vmcnt(5) lgkmcnt(8)
    v_mfma_f32_32x32x16_bf16 v[196:211], v[48:51], v[136:139], v[196:211]
    ds_read_b64_tr_b16 v[40:41], v243 offset:26624
    ds_read_b64_tr_b16 v[42:43], v243 offset:27648
    ds_read_b64_tr_b16 v[44:45], v248 offset:26624
    ds_read_b64_tr_b16 v[46:47], v248 offset:27648
    v_mfma_f32_32x32x16_bf16 v[212:227], v[52:55], v[136:139], v[212:227]
    s_waitcnt vmcnt(4) lgkmcnt(8)
    v_mfma_f32_32x32x16_bf16 v[196:211], v[56:59], v[140:143], v[196:211]
    ds_read_b64_tr_b16 v[48:49], v243 offset:28672
    ds_read_b64_tr_b16 v[50:51], v243 offset:29696
    ds_read_b64_tr_b16 v[52:53], v248 offset:28672
    ds_read_b64_tr_b16 v[54:55], v248 offset:29696
    v_mfma_f32_32x32x16_bf16 v[212:227], v[60:63], v[140:143], v[212:227]
    s_waitcnt vmcnt(3) lgkmcnt(8)
    v_mfma_f32_32x32x16_bf16 v[196:211], v[32:35], v[144:147], v[196:211]
    ds_read_b64_tr_b16 v[56:57], v243 offset:30720
    ds_read_b64_tr_b16 v[58:59], v243 offset:31744
    ds_read_b64_tr_b16 v[60:61], v248 offset:30720
    ds_read_b64_tr_b16 v[62:63], v248 offset:31744
    s_waitcnt vmcnt(2) lgkmcnt(8)
    v_mfma_f32_32x32x16_bf16 v[196:211], v[40:43], v[0:3], v[196:211]
    s_waitcnt vmcnt(1) lgkmcnt(4)
    v_mfma_f32_32x32x16_bf16 v[196:211], v[48:51], v[4:7], v[196:211]
    s_waitcnt vmcnt(0) lgkmcnt(0)
    v_mfma_f32_32x32x16_bf16 v[196:211], v[56:59], v[8:11], v[196:211]
    v_mfma_f32_32x32x16_bf16 v[212:227], v[36:39], v[144:147], v[212:227]
    s_nop 4
    v_mfma_f32_32x32x16_bf16 v[212:227], v[44:47], v[0:3], v[212:227]
    s_nop 4
    ds_write_b128 v74, v[196:199] offset:0
    v_mfma_f32_32x32x16_bf16 v[212:227], v[52:55], v[4:7], v[212:227]
    ds_write_b128 v75, v[200:203] offset:0
    v_mfma_f32_32x32x16_bf16 v[212:227], v[60:63], v[8:11], v[212:227]
    ds_write_b128 v76, v[204:207] offset:0
    ds_write_b128 v77, v[208:211] offset:0
    s_nop 9
    ds_write_b128 v74, v[212:215] offset:128
    ds_write_b128 v75, v[216:219] offset:128
    ds_write_b128 v76, v[220:223] offset:128
    ds_write_b128 v77, v[224:227] offset:128
    s_waitcnt lgkmcnt(0)
    s_barrier
    s_endpgm
L_TC:
L_pad6:
    s_cbranch_execz L_wret
    s_waitcnt lgkmcnt(4)
    v_mfma_f32_32x32x16_bf16 v[196:211], v[32:35], v[188:191], v[196:211]
    ds_read_b64_tr_b16 v[48:49], v243 offset:16384
    ds_read_b64_tr_b16 v[50:51], v243 offset:17408
    ds_read_b64_tr_b16 v[52:53], v248 offset:16384
    ds_read_b64_tr_b16 v[54:55], v248 offset:17408
    v_mfma_f32_32x32x16_bf16 v[212:227], v[36:39], v[188:191], v[212:227]
    s_add_u32 m0, s12, 98304
    s_add_u32 s76, s76, 0x10000
    buffer_load_dwordx4 v239, s[36:39], s76 offen lds
    v_and_b32 v240, 7, v252
    v_lshrrev_b32 v66, 3, v252
    v_mov_b32 v67, 1
    v_lshlrev_b32 v65, 7, v252
    s_and_b32 s78, s3, 0xfffff800
    s_waitcnt lgkmcnt(4)
    v_mfma_f32_32x32x16_bf16 v[196:211], v[40:43], v[192:195], v[196:211]
    ds_read_b64_tr_b16 v[56:57], v243 offset:24576
    ds_read_b64_tr_b16 v[58:59], v243 offset:25600
    ds_read_b64_tr_b16 v[60:61], v248 offset:24576
    ds_read_b64_tr_b16 v[62:63], v248 offset:25600
    v_mfma_f32_32x32x16_bf16 v[212:227], v[44:47], v[192:195], v[212:227]
    s_add_u32 m0, s12, 106496
    s_add_u32 s76, s76, 0x10000
    buffer_load_dwordx4 v239, s[36:39], s76 offen lds
    s_lshr_b32 s74, s71, 3
    s_lshl2_add_u32 s78, s74, s78
    s_lshl_b32 s74, s69, 2
    s_mov_b32 s21, 0
    s_lshl_b32 s20, 15, s74
    s_waitcnt lgkmcnt(4)
    v_mfma_f32_32x32x16_bf16 v[196:211], v[48:51], v[148:151], v[196:211]
    ds_read_b64_tr_b16 v[32:33], v243 offset:32768
    ds_read_b64_tr_b16 v[34:35], v243 offset:33792
    ds_read_b64_tr_b16 v[36:37], v248 offset:32768
    ds_read_b64_tr_b16 v[38:39], v248 offset:33792
    v_mfma_f32_32x32x16_bf16 v[212:227], v[52:55], v[148:151], v[212:227]
    s_add_u32 m0, s12, 114688
    s_add_u32 s76, s76, 0x10000
    buffer_load_dwordx4 v239, s[36:39], s76 offen lds
    s_bitset0_b32 s20, s71
    v_xor_b32 v74, v240, v253
    v_lshlrev_b32 v74, 4, v74
    v_lshl_add_u32 v74, v254, 8, v74
    s_lshl_b32 s74, s68, 13
    s_waitcnt lgkmcnt(4)
    v_mfma_f32_32x32x16_bf16 v[196:211], v[56:59], v[152:155], v[196:211]
    ds_read_b64_tr_b16 v[40:41], v243 offset:40960
    ds_read_b64_tr_b16 v[42:43], v243 offset:41984
    ds_read_b64_tr_b16 v[44:45], v248 offset:40960
    ds_read_b64_tr_b16 v[46:47], v248 offset:41984
    v_mfma_f32_32x32x16_bf16 v[212:227], v[60:63], v[152:155], v[212:227]
    s_add_u32 m0, s12, 122880
    s_add_u32 s76, s76, 0x10000
    buffer_load_dwordx4 v239, s[36:39], s76 offen lds
    v_add_u32 v74, s74, v74
    v_xor_b32 v75, 32, v74
    v_xor_b32 v76, 64, v74
    v_xor_b32 v77, 0x60, v74
    v_lshlrev_b32 v78, 1, v240
    s_waitcnt lgkmcnt(4)
    v_mfma_f32_32x32x16_bf16 v[196:211], v[32:35], v[156:159], v[196:211]
    ds_read_b64_tr_b16 v[48:49], v243 offset:49152
    ds_read_b64_tr_b16 v[50:51], v243 offset:50176
    ds_read_b64_tr_b16 v[52:53], v248 offset:49152
    ds_read_b64_tr_b16 v[54:55], v248 offset:50176
    v_mfma_f32_32x32x16_bf16 v[212:227], v[36:39], v[156:159], v[212:227]
    s_add_u32 m0, s12, 131072
    s_add_u32 s76, s76, 0x10000
    buffer_load_dwordx4 v239, s[36:39], s76 offen lds
    v_xor_b32 v78, v78, v66
    v_lshlrev_b32 v78, 4, v78
    v_lshl_add_u32 v78, v66, 8, v78
    s_lshl_b32 s74, s69, 11
    v_add_u32 v78, s74, v78
    s_waitcnt vmcnt(5)
    s_barrier
    s_mov_b64 exec, s[20:21]
    buffer_atomic_add v67, v65, s[52:55], s78 offen offset:32 sc1
    s_mov_b64 exec, -1
    s_waitcnt lgkmcnt(4)
    v_mfma_f32_32x32x16_bf16 v[196:211], v[40:43], v[160:163], v[196:211]
    ds_read_b64_tr_b16 v[56:57], v243 offset:57344
    ds_read_b64_tr_b16 v[58:59], v243 offset:58368
    ds_read_b64_tr_b16 v[60:61], v248 offset:57344
    ds_read_b64_tr_b16 v[62:63], v248 offset:58368
    s_add_u32 m0, s12, 139264
    s_add_u32 s76, s76, 0x10000
    buffer_load_dwordx4 v239, s[36:39], s76 offen lds
    v_mfma_f32_32x32x16_bf16 v[212:227], v[44:47], v[160:163], v[212:227]
    s_add_u32 m0, s12, 147456
    s_add_u32 s76, s76, 0x10000
    buffer_load_dwordx4 v239, s[36:39], s76 offen lds
    v_xor_b32 v79, 16, v78
    v_mul_f32 v249, v249, v249
    v_mul_f32 v250, v250, v250
    v_lshlrev_b32 v80, 16, v116
    s_waitcnt lgkmcnt(4)
    v_mfma_f32_32x32x16_bf16 v[196:211], v[48:51], v[164:167], v[196:211]
    v_add_u32 v243, 65536, v243
    ds_read_b64_tr_b16 v[32:33], v243 offset:0
    ds_read_b64_tr_b16 v[34:35], v243 offset:1024
    v_add_u32 v248, 65536, v248
    ds_read_b64_tr_b16 v[36:37], v248 offset:0
    ds_read_b64_tr_b16 v[38:39], v248 offset:1024
    s_add_u32 m0, s12, 155648
    s_add_u32 s76, s76, 0x10000
    buffer_load_dwordx4 v239, s[36:39], s76 offen lds
    v_mfma_f32_32x32x16_bf16 v[212:227], v[52:55], v[164:167], v[212:227]
    v_and_b32 v81, 0xffff0000, v116
    v_lshlrev_b32 v82, 16, v117
    v_and_b32 v83, 0xffff0000, v117
    v_lshlrev_b32 v84, 16, v118
    v_and_b32 v85, 0xffff0000, v118
    s_waitcnt lgkmcnt(4)
    v_mfma_f32_32x32x16_bf16 v[196:211], v[56:59], v[168:171], v[196:211]
    ds_read_b64_tr_b16 v[40:41], v243 offset:8192
    ds_read_b64_tr_b16 v[42:43], v243 offset:9216
    ds_read_b64_tr_b16 v[44:45], v248 offset:8192
    ds_read_b64_tr_b16 v[46:47], v248 offset:9216
    v_mfma_f32_32x32x16_bf16 v[212:227], v[60:63], v[168:171], v[212:227]
    v_lshlrev_b32 v86, 16, v119
    v_and_b32 v87, 0xffff0000, v119
    v_lshlrev_b32 v16, 16, v132
    v_and_b32 v17, 0xffff0000, v132
    v_lshlrev_b32 v18, 16, v133
    s_barrier
    s_waitcnt lgkmcnt(4)
    v_mfma_f32_32x32x16_bf16 v[196:211], v[32:35], v[172:175], v[196:211]
    ds_read_b64_tr_b16 v[48:49], v243 offset:16384
    ds_read_b64_tr_b16 v[50:51], v243 offset:17408
    ds_read_b64_tr_b16 v[52:53], v248 offset:16384
    ds_read_b64_tr_b16 v[54:55], v248 offset:17408
    v_mfma_f32_32x32x16_bf16 v[212:227], v[36:39], v[172:175], v[212:227]
    v_and_b32 v19, 0xffff0000, v133
    v_lshlrev_b32 v20, 16, v134
    v_and_b32 v21, 0xffff0000, v134
    v_lshlrev_b32 v22, 16, v135
    v_and_b32 v23, 0xffff0000, v135
    s_waitcnt lgkmcnt(4)
    v_mfma_f32_32x32x16_bf16 v[196:211], v[40:43], v[176:179], v[196:211]
    ds_read_b64_tr_b16 v[56:57], v243 offset:24576
    ds_read_b64_tr_b16 v[58:59], v243 offset:25600
    ds_read_b64_tr_b16 v[60:61], v248 offset:24576
    ds_read_b64_tr_b16 v[62:63], v248 offset:25600
    v_mfma_f32_32x32x16_bf16 v[212:227], v[44:47], v[176:179], v[212:227]
    v_lshlrev_b32 v24, 16, v136
    v_and_b32 v25, 0xffff0000, v136
    v_lshlrev_b32 v26, 16, v137
    v_and_b32 v27, 0xffff0000, v137
    v_lshlrev_b32 v28, 16, v138
    s_waitcnt lgkmcnt(4)
    v_mfma_f32_32x32x16_bf16 v[196:211], v[48:51], v[180:183], v[196:211]
    v_mfma_f32_32x32x16_bf16 v[212:227], v[52:55], v[180:183], v[212:227]
    v_and_b32 v29, 0xffff0000, v138
    v_lshlrev_b32 v30, 16, v139
    v_and_b32 v31, 0xffff0000, v139
    s_waitcnt lgkmcnt(0)
    v_mfma_f32_32x32x16_bf16 v[196:211], v[56:59], v[184:187], v[196:211]
    v_mfma_f32_32x32x16_bf16 v[212:227], v[60:63], v[184:187], v[212:227]
    s_nop 10
    ds_write_b128 v74, v[196:199] offset:0
    ds_write_b128 v75, v[200:203] offset:0
    ds_write_b128 v76, v[204:207] offset:0
    ds_write_b128 v77, v[208:211] offset:0
    ds_write_b128 v74, v[212:215] offset:128
    ds_write_b128 v75, v[216:219] offset:128
    ds_write_b128 v76, v[220:223] offset:128
    ds_write_b128 v77, v[224:227] offset:128
    s_waitcnt vmcnt(0) lgkmcnt(0)
    s_barrier
    ds_read_b128 v[0:3], v78 offset:0
    ds_read_b128 v[4:7], v79 offset:0
    ds_read_b128 v[148:151], v78 offset:16384
    ds_read_b128 v[152:155], v79 offset:16384
    ds_read_b128 v[156:159], v78 offset:32768
    ds_read_b128 v[160:163], v79 offset:32768
    ds_read_b128 v[164:167], v78 offset:49152
    ds_read_b128 v[168:171], v79 offset:49152
    ds_read_b128 v[8:11], v78 offset:8192
    ds_read_b128 v[12:15], v79 offset:8192
    ds_read_b128 v[172:175], v78 offset:24576
    ds_read_b128 v[176:179], v79 offset:24576
    ds_read_b128 v[180:183], v78 offset:40960
    ds_read_b128 v[184:187], v79 offset:40960
    s_waitcnt lgkmcnt(12)
    ds_read_b128 v[188:191], v78 offset:57344
    ds_read_b128 v[192:195], v79 offset:57344
    s_waitcnt lgkmcnt(12)
    v_add_f32 v0, v0, v148
    v_add_f32 v1, v1, v149
    v_add_f32 v2, v2, v150
    v_add_f32 v3, v3, v151
    v_add_f32 v4, v4, v152
    v_add_f32 v5, v5, v153
    v_add_f32 v6, v6, v154
    v_add_f32 v7, v7, v155
    s_waitcnt lgkmcnt(10)
    v_add_f32 v0, v0, v156
    v_add_f32 v1, v1, v157
    v_add_f32 v2, v2, v158
    v_add_f32 v3, v3, v159
    v_add_f32 v4, v4, v160
    v_add_f32 v5, v5, v161
    v_add_f32 v6, v6, v162
    v_add_f32 v7, v7, v163
    s_waitcnt lgkmcnt(8)
    v_add_f32 v0, v0, v164
    v_add_f32 v1, v1, v165
    v_add_f32 v2, v2, v166
    v_add_f32 v3, v3, v167
    v_add_f32 v4, v4, v168
    v_add_f32 v5, v5, v169
    v_add_f32 v6, v6, v170
    v_add_f32 v7, v7, v171
    s_waitcnt lgkmcnt(4)
    v_add_f32 v8, v8, v172
    v_add_f32 v9, v9, v173
    v_add_f32 v10, v10, v174
    v_add_f32 v11, v11, v175
    v_add_f32 v12, v12, v176
    v_add_f32 v13, v13, v177
    v_add_f32 v14, v14, v178
    v_add_f32 v15, v15, v179
    s_waitcnt lgkmcnt(2)
    v_add_f32 v8, v8, v180
    v_add_f32 v9, v9, v181
    v_add_f32 v10, v10, v182
    v_add_f32 v11, v11, v183
    v_add_f32 v12, v12, v184
    v_add_f32 v13, v13, v185
    v_add_f32 v14, v14, v186
    v_add_f32 v15, v15, v187
    s_waitcnt lgkmcnt(0)
    v_add_f32 v8, v8, v188
    v_add_f32 v9, v9, v189
    v_add_f32 v10, v10, v190
    v_add_f32 v11, v11, v191
    v_add_f32 v12, v12, v192
    v_add_f32 v13, v13, v193
    v_add_f32 v14, v14, v194
    v_add_f32 v15, v15, v195
    v_fma_f32 v0, v0, v249, v80
    v_fma_f32 v1, v1, v249, v81
    v_fma_f32 v2, v2, v249, v82
    v_fma_f32 v3, v3, v249, v83
    v_fma_f32 v4, v4, v249, v84
    v_fma_f32 v5, v5, v249, v85
    v_fma_f32 v6, v6, v249, v86
    v_fma_f32 v7, v7, v249, v87
    v_fma_f32 v8, v8, v250, v80
    v_fma_f32 v9, v9, v250, v81
    v_fma_f32 v10, v10, v250, v82
    v_fma_f32 v11, v11, v250, v83
    v_fma_f32 v12, v12, v250, v84
    v_fma_f32 v13, v13, v250, v85
    v_fma_f32 v14, v14, v250, v86
    v_fma_f32 v15, v15, v250, v87
    v_mul_f32 v32, 0xbfb8aa3b, v0
    v_mul_f32 v33, 0xbfb8aa3b, v1
    v_mul_f32 v34, 0xbfb8aa3b, v2
    v_mul_f32 v35, 0xbfb8aa3b, v3
    v_mul_f32 v36, 0xbfb8aa3b, v4
    v_mul_f32 v37, 0xbfb8aa3b, v5
    v_mul_f32 v38, 0xbfb8aa3b, v6
    v_mul_f32 v39, 0xbfb8aa3b, v7
    v_mul_f32 v40, 0xbfb8aa3b, v8
    v_mul_f32 v41, 0xbfb8aa3b, v9
    v_mul_f32 v42, 0xbfb8aa3b, v10
    v_mul_f32 v43, 0xbfb8aa3b, v11
    v_mul_f32 v44, 0xbfb8aa3b, v12
    v_mul_f32 v45, 0xbfb8aa3b, v13
    v_mul_f32 v46, 0xbfb8aa3b, v14
    v_mul_f32 v47, 0xbfb8aa3b, v15
    v_exp_f32 v32, v32
    v_exp_f32 v33, v33
    v_exp_f32 v34, v34
    v_exp_f32 v35, v35
    v_exp_f32 v36, v36
    v_exp_f32 v37, v37
    v_exp_f32 v38, v38
    v_exp_f32 v39, v39
    v_exp_f32 v40, v40
    v_exp_f32 v41, v41
    v_exp_f32 v42, v42
    v_exp_f32 v43, v43
    v_exp_f32 v44, v44
    v_exp_f32 v45, v45
    v_exp_f32 v46, v46
    v_exp_f32 v47, v47
    v_add_f32 v32, 1.0, v32
    v_add_f32 v33, 1.0, v33
    v_add_f32 v34, 1.0, v34
    v_add_f32 v35, 1.0, v35
    v_add_f32 v36, 1.0, v36
    v_add_f32 v37, 1.0, v37
    v_add_f32 v38, 1.0, v38
    v_add_f32 v39, 1.0, v39
    v_add_f32 v40, 1.0, v40
    v_add_f32 v41, 1.0, v41
    v_add_f32 v42, 1.0, v42
    v_add_f32 v43, 1.0, v43
    v_add_f32 v44, 1.0, v44
    v_add_f32 v45, 1.0, v45
    v_add_f32 v46, 1.0, v46
    v_add_f32 v47, 1.0, v47
    v_rcp_f32 v32, v32
    v_rcp_f32 v33, v33
    v_rcp_f32 v34, v34
    v_rcp_f32 v35, v35
    v_rcp_f32 v36, v36
    v_rcp_f32 v37, v37
    v_rcp_f32 v38, v38
    v_rcp_f32 v39, v39
    v_rcp_f32 v40, v40
    v_rcp_f32 v41, v41
    v_rcp_f32 v42, v42
    v_rcp_f32 v43, v43
    v_rcp_f32 v44, v44
    v_rcp_f32 v45, v45
    v_rcp_f32 v46, v46
    v_rcp_f32 v47, v47
    v_add_u32 v78, 65536, v78
    v_add_u32 v79, 65536, v79
    v_mul_f32 v0, v0, v32
    v_mul_f32 v1, v1, v33
    v_mul_f32 v2, v2, v34
    v_mul_f32 v3, v3, v35
    v_mul_f32 v4, v4, v36
    v_mul_f32 v5, v5, v37
    v_mul_f32 v6, v6, v38
    v_mul_f32 v7, v7, v39
    v_mul_f32 v8, v8, v40
    v_mul_f32 v9, v9, v41
    v_mul_f32 v10, v10, v42
    v_mul_f32 v11, v11, v43
    v_mul_f32 v12, v12, v44
    v_mul_f32 v13, v13, v45
    v_mul_f32 v14, v14, v46
    v_mul_f32 v15, v15, v47
    s_barrier
    ds_read_b128 v[148:151], v78 offset:0
    ds_read_b128 v[152:155], v79 offset:0
    ds_read_b128 v[156:159], v78 offset:16384
    ds_read_b128 v[160:163], v79 offset:16384
    ds_read_b128 v[164:167], v78 offset:8192
    ds_read_b128 v[168:171], v79 offset:8192
    ds_read_b128 v[172:175], v78 offset:24576
    ds_read_b128 v[176:179], v79 offset:24576
    s_waitcnt lgkmcnt(4)
    v_pk_add_f32 v[148:149], v[148:149], v[156:157]
    v_pk_add_f32 v[150:151], v[150:151], v[158:159]
    v_pk_add_f32 v[152:153], v[152:153], v[160:161]
    v_pk_add_f32 v[154:155], v[154:155], v[162:163]
    v_pk_fma_f32 v[148:149], v[148:149], v[0:1], v[16:17]
    v_pk_fma_f32 v[150:151], v[150:151], v[2:3], v[18:19]
    v_pk_fma_f32 v[152:153], v[152:153], v[4:5], v[20:21]
    v_pk_fma_f32 v[154:155], v[154:155], v[6:7], v[22:23]
    v_cvt_pk_bf16_f32 v32, v148, v149
    v_cvt_pk_bf16_f32 v33, v150, v151
    v_cvt_pk_bf16_f32 v34, v152, v153
    v_cvt_pk_bf16_f32 v35, v154, v155
    buffer_store_dwordx4 v[32:35], v245, s[48:51], s15 offen sc1 nt
    s_waitcnt lgkmcnt(0)
    v_pk_add_f32 v[164:165], v[164:165], v[172:173]
    v_pk_add_f32 v[166:167], v[166:167], v[174:175]
    v_pk_add_f32 v[168:169], v[168:169], v[176:177]
    v_pk_add_f32 v[170:171], v[170:171], v[178:179]
    v_pk_fma_f32 v[164:165], v[164:165], v[8:9], v[24:25]
    v_pk_fma_f32 v[166:167], v[166:167], v[10:11], v[26:27]
    v_pk_fma_f32 v[168:169], v[168:169], v[12:13], v[28:29]
    v_pk_fma_f32 v[170:171], v[170:171], v[14:15], v[30:31]
    v_cvt_pk_bf16_f32 v36, v164, v165
    v_cvt_pk_bf16_f32 v37, v166, v167
    v_cvt_pk_bf16_f32 v38, v168, v169
    v_cvt_pk_bf16_f32 v39, v170, v171
    buffer_store_dwordx4 v[36:39], v245, s[48:51], s22 offen sc1 nt
L_DONE:
    s_endpgm
L_SLOW:
    s_nop 7
    s_lshr_b32 s73, s4, 17
    s_lshl_b32 s73, s73, 17
    s_mov_b32 s74, 64
    v_mov_b32 v66, 0xff800000
L_S1:
    buffer_load_dwordx4 v[112:115], v237, s[52:55], s73 offen sc1
    s_waitcnt vmcnt(0)
    v_mfma_f32_32x32x16_bf16 v[80:95], v[112:115], v[96:99], 0
    s_nop 11
    v_max3_f32 v66, v66, v80, v81
    v_max3_f32 v66, v66, v82, v83
    v_max3_f32 v66, v66, v84, v85
    v_max3_f32 v66, v66, v86, v87
    v_max3_f32 v66, v66, v88, v89
    v_max3_f32 v66, v66, v90, v91
    v_max3_f32 v66, v66, v92, v93
    v_max3_f32 v66, v66, v94, v95
    s_add_u32 s73, s73, 2048
    s_sub_u32 s74, s74, 1
    s_cmp_lg_u32 s74, 0
    s_cbranch_scc1 L_S1
    v_mov_b32 v67, v66
    s_nop 1
    v_permlane32_swap_b32 v66, v67
    v_max_f32 v66, v66, v67
    s_sub_u32 s73, s73, 0x20000
    s_mov_b32 s74, 64
    v_sub_f32 v16, 0, v66
    v_mov_b32 v0, 0
    v_sub_f32 v17, 0, v66
    v_mov_b32 v1, 0
    v_sub_f32 v18, 0, v66
    v_mov_b32 v2, 0
    v_sub_f32 v19, 0, v66
    v_mov_b32 v3, 0
    v_sub_f32 v20, 0, v66
    v_mov_b32 v4, 0
    v_sub_f32 v21, 0, v66
    v_mov_b32 v5, 0
    v_sub_f32 v22, 0, v66
    v_mov_b32 v6, 0
    v_sub_f32 v23, 0, v66
    v_mov_b32 v7, 0
    v_sub_f32 v24, 0, v66
    v_mov_b32 v8, 0
    v_sub_f32 v25, 0, v66
    v_mov_b32 v9, 0
    v_sub_f32 v26, 0, v66
    v_mov_b32 v10, 0
    v_sub_f32 v27, 0, v66
    v_mov_b32 v11, 0
    v_sub_f32 v28, 0, v66
    v_mov_b32 v12, 0
    v_sub_f32 v29, 0, v66
    v_mov_b32 v13, 0
    v_sub_f32 v30, 0, v66
    v_mov_b32 v14, 0
    v_sub_f32 v31, 0, v66
    v_mov_b32 v15, 0
L_S2:
    buffer_load_dwordx4 v[112:115], v237, s[52:55], s73 offen sc1
    s_mov_b64 exec, s[26:27]
    buffer_load_dwordx4 v[140:143], v238, s[52:55], s73 offen offset:1024 sc1
    buffer_load_dwordx4 v[144:147], v238, s[52:55], s73 offen offset:1536 sc1
    s_mov_b64 exec, -1
    s_waitcnt vmcnt(0)
    v_mfma_f32_32x32x16_bf16 v[80:95], v[112:115], v[96:99], v[16:31]
    s_nop 11
    v_exp_f32 v80, v80
    v_exp_f32 v81, v81
    v_exp_f32 v82, v82
    v_exp_f32 v83, v83
    v_exp_f32 v84, v84
    v_exp_f32 v85, v85
    v_exp_f32 v86, v86
    v_exp_f32 v87, v87
    v_exp_f32 v88, v88
    v_exp_f32 v89, v89
    v_exp_f32 v90, v90
    v_exp_f32 v91, v91
    v_exp_f32 v92, v92
    v_exp_f32 v93, v93
    v_exp_f32 v94, v94
    v_exp_f32 v95, v95
    v_smfmac_f32_32x32x32_bf16 v[0:15], v[140:143], v[80:87], v236
    s_nop 0
    v_smfmac_f32_32x32x32_bf16 v[0:15], v[144:147], v[88:95], v236
    s_add_u32 s73, s73, 2048
    s_sub_u32 s74, s74, 1
    s_cmp_lg_u32 s74, 0
    s_cbranch_scc1 L_S2
    s_nop 15
    v_rcp_f32 v66, v8
    s_nop 0
    v_pk_mul_f32 v[0:1], v[0:1], v[66:67] op_sel_hi:[1,0]
    v_pk_mul_f32 v[2:3], v[2:3], v[66:67] op_sel_hi:[1,0]
    v_pk_mul_f32 v[4:5], v[4:5], v[66:67] op_sel_hi:[1,0]
    v_pk_mul_f32 v[6:7], v[6:7], v[66:67] op_sel_hi:[1,0]
    v_cvt_pk_bf16_f32 v68, v0, v1
    v_cvt_pk_bf16_f32 v69, v2, v3
    v_cvt_pk_bf16_f32 v70, v4, v5
    v_cvt_pk_bf16_f32 v71, v6, v7
    buffer_store_dwordx4 v[68:71], v237, s[52:55], s14 offen sc1
    s_branch L_NORM
L_exit:
    s_waitcnt vmcnt(0) lgkmcnt(0)
L_end:
    s_endpgm
.section .rodata,"a"
.p2align 6
.amdhsa_kernel recurrent_scan__softmax_full_mha__dense_activation_squared_relu__prompt_kernel
  .amdhsa_next_free_vgpr 256
  .amdhsa_next_free_sgpr 102
  .amdhsa_accum_offset 256
  .amdhsa_group_segment_fixed_size 0
  .amdhsa_kernarg_size 88
  .amdhsa_user_sgpr_count 2
  .amdhsa_user_sgpr_kernarg_segment_ptr 1
  .amdhsa_system_sgpr_workgroup_id_x 1
  .amdhsa_float_denorm_mode_32 3
.end_amdhsa_kernel
```
